```python
import torch

def _softmax(x, axis=-1):
    return torch.softmax(x, dim=axis)
def _gelu(x):
    return torch.nn.functional.gelu(x, approximate="tanh")
def _silu(x):
    return torch.nn.functional.silu(x)
def _sigmoid(x):
    return torch.sigmoid(x)
def _layernorm(x, axis=-1, eps=1e-5):
    m = x.mean(dim=axis, keepdim=True)
    v = x.var(dim=axis, keepdim=True, unbiased=False)
    return (x - m) / torch.sqrt(v + eps)
def _scatter_add(tgt, idx, src, axis=0):
    return tgt.clone().index_add_(axis, idx, src)
def _segment_sum(src, seg, n):
    out = torch.zeros((n,) + src.shape[1:], dtype=src.dtype)
    return out.index_add_(0, seg, src)
def _pad(x, pw):
    flat = tuple(v for pair in reversed(pw) for v in pair)
    return torch.nn.functional.pad(x, flat)

kernel_name = 'gated_mix__ssm_conv_s4__ssm_conv_h3__prompt'

def setup_inputs():

    _w = (lambda a: (lambda t: t.to(torch.bfloat16) if t.is_floating_point() else t)(torch.as_tensor(a)))
    def _A_setup():
        B, L, D, N = 1, 2048, 512, 128
        A_re = -(lambda _x: torch.exp(torch.as_tensor(_x)))((lambda *s: torch.randn(*s, dtype=torch.bfloat16) * 6.4)(D, N))
        A_im = torch.pi * (lambda *s: torch.randn(*s, dtype=torch.bfloat16) * 0.05)(D, N)
        B_re = (lambda *s: torch.randn(*s, dtype=torch.bfloat16) * 0.1)(D, N)
        B_im = (lambda *s: torch.randn(*s, dtype=torch.bfloat16) * 0.1)(D, N)
        C_re = (lambda *s: torch.randn(*s, dtype=torch.bfloat16) * 0.1)(D, N)
        C_im = (lambda *s: torch.randn(*s, dtype=torch.bfloat16) * 0.1)(D, N)
        log_dt = (lambda *s: torch.randn(*s, dtype=torch.bfloat16) * 0.05)(D) * 0.5 - 4.0
        Dskip = (lambda *s: torch.randn(*s, dtype=torch.bfloat16) * 0.05)(D)
        return {
            "u": _w((lambda *s: torch.randn(*s, dtype=torch.bfloat16) * 0.05)(B, L, D)),
            "A_re": _w(A_re),
            "A_im": _w(A_im),
            "B_re": _w(B_re),
            "B_im": _w(B_im),
            "C_re": _w(C_re),
            "C_im": _w(C_im),
            "log_dt": _w(log_dt),
            "Dskip": _w(Dskip),
        }
    _A_in = _A_setup()

    def _B_setup():
        B, S, D = 1, 2048, 512
        ks = 4
        return {
            "q": _w((lambda *s: torch.randn(*s, dtype=torch.bfloat16) * 0.05)(B, S, D)),
            "k": _w((lambda *s: torch.randn(*s, dtype=torch.bfloat16) * 0.4)(B, S, D)),
            "v": _w((lambda *s: torch.randn(*s, dtype=torch.bfloat16) * 0.4)(B, S, D)),
            "shift_k": _w((lambda *s: torch.randn(*s, dtype=torch.bfloat16) * 0.4)(D, ks) * 0.5),
            "ssm_k": _w((lambda *s: torch.randn(*s, dtype=torch.bfloat16) * 0.4)(D, S) * (1.0 / S ** 0.5)),
            "ssm_D": _w((lambda *s: torch.randn(*s, dtype=torch.bfloat16) * 0.4)(D)),
        }
    _B_in = _B_setup()

    return {
        "A_u": _A_in["u"],
        "A_A_re": _A_in["A_re"],
        "A_A_im": _A_in["A_im"],
        "A_B_re": _A_in["B_re"],
        "A_B_im": _A_in["B_im"],
        "A_C_re": _A_in["C_re"],
        "A_C_im": _A_in["C_im"],
        "A_log_dt": _A_in["log_dt"],
        "A_Dskip": _A_in["Dskip"],
        "B_q": _B_in["q"],
        "B_k": _B_in["k"],
        "B_v": _B_in["v"],
        "B_shift_k": _B_in["shift_k"],
        "B_ssm_k": _B_in["ssm_k"],
        "B_ssm_D": _B_in["ssm_D"],
        "gate_w": _w((lambda *s: torch.randn(*s, dtype=torch.bfloat16) * 0.05)(512) * 16.0),
    }

def reference(A_u, A_A_re, A_A_im, A_B_re, A_B_im, A_C_re, A_C_im, A_log_dt, A_Dskip, B_q, B_k, B_v, B_shift_k, B_ssm_k, B_ssm_D, gate_w):
    def _A_ref(u, A_re, A_im, B_re, B_im, C_re, C_im, log_dt, Dskip):
        Bsz, L, D = u.shape
        dt = torch.exp(log_dt)[:, None]
        A = A_re + 1j * A_im
        Bc = B_re + 1j * B_im
        Cc = C_re + 1j * C_im
        logdA = dt * A
        dB = dt * Bc
        l = (lambda x, dt: x.to(dt))(torch.arange(L), A_re.dtype)
        P = torch.exp(logdA[:, :, None] * l[None, None, :])
        K = torch.einsum("dn,dnl,dn->dl", Cc, P, dB).real
        L2 = 2 * L
        Kp = _pad(K, ((0, 0), (0, L)))
        up = (lambda x, *d: x.permute(*d))(u, 0, 2, 1)
        up = _pad(up, ((0, 0), (0, 0), (0, L)))
        Kf = (lambda x, axes=(-2,-1): torch.fft.rfft2(x.float(), dim=axes))(Kp[:, None, :], axes=(-2, -1))
        Uf = (lambda x, axes=(-2,-1): torch.fft.rfft2(x.float(), dim=axes))(up[:, :, None, :], axes=(-2, -1))
        Yf = Uf * Kf[None, :, :, :]
        y = (lambda x, s, axes=(-2,-1): torch.fft.irfft2(x, s=s, dim=axes).to(torch.bfloat16))(Yf, (1, L2), axes=(-2, -1))[:, :, 0, :L]
        y = (lambda x, *d: x.permute(*d))(y, 0, 2, 1) + u * Dskip[None, None, :]
        return y

    def _B_ref(q, k, v, shift_k, ssm_k, ssm_D):
        B, S, D = q.shape
        ks = shift_k.shape[-1]
        k_pad = _pad(k, ((0, 0), (ks - 1, 0), (0, 0)))
        k_shift = torch.zeros_like(k)
        for t in range(ks):
            k_shift = k_shift + k_pad[:, t:t + S, :] * shift_k[:, ks - 1 - t][None, None, :]
        kv = k_shift * v
        L = 2 * S
        kv_pad = _pad(kv, ((0, 0), (0, S), (0, 0)))
        kf_pad = _pad(ssm_k, ((0, 0), (0, S)))
        kv_f = (lambda x, axes=(-2,-1): torch.fft.rfft2(x.float(), dim=axes))(kv_pad[:, None, :, :], axes=(1, 2))
        kf_f = (lambda x, axes=(-2,-1): torch.fft.rfft2(x.float(), dim=axes))(kf_pad[:, None, :], axes=(1, 2))
        kf_f = (lambda x, *d: x.permute(*d))(kf_f, 1, 2, 0)
        y_f = kv_f * kf_f[None, :, :, :]
        y = (lambda x, s, axes=(-2,-1): torch.fft.irfft2(x, s=s, dim=axes).to(torch.bfloat16))(y_f, (1, L), axes=(1, 2))[:, 0, :S, :]
        y = y + kv * ssm_D[None, None, :]
        return q * y

    x = A_u
    g = _sigmoid((x * gate_w).sum(-1, keepdims=True))
    a = _A_ref(x, A_A_re, A_A_im, A_B_re, A_B_im, A_C_re, A_C_im, A_log_dt, A_Dskip)
    b = _B_ref(x, B_k, B_v, B_shift_k, B_ssm_k, B_ssm_D)
    return g * a + (1 - g) * b
```

```asm
; @launch grid=(256,1,1) block=(512,1,1) lds=159584
.amdgcn_target "amdgcn-amd-amdhsa--gfx950"
.text
.globl gated_mix__ssm_conv_s4__ssm_conv_h3__prompt_kernel
.p2align 8
.type gated_mix__ssm_conv_s4__ssm_conv_h3__prompt_kernel,@function
gated_mix__ssm_conv_s4__ssm_conv_h3__prompt_kernel:
    s_cmp_ge_u32 s2, 256
    s_cbranch_scc1 K_end
    s_setprio 3
    s_load_dwordx16 s[4:19], s[0:1], 0
    s_load_dwordx2 s[20:21], s[0:1], 64
    s_load_dwordx8 s[24:31], s[0:1], 80
    s_load_dwordx8 s[32:39], s[0:1], 112
    s_load_dwordx2 s[40:41], s[0:1], 144
    v_lshrrev_b32 v1, 6, v0
    s_nop 0
    v_readfirstlane_b32 s3, v1
    v_and_b32 v1, 63, v0
    s_and_b32 s64, s2, 7
    s_lshl_b32 s65, s64, 2
    s_lshl_b32 s64, s64, 5
    s_lshr_b32 s66, s2, 3
    s_add_u32 s64, s64, s66
    s_and_b32 s66, s66, 3
    s_add_u32 s65, s65, s66
    s_lshr_b32 s66, s2, 5
    s_and_b32 s67, s3, 3
    s_lshr_b32 s68, s3, 2
    s_bfe_u32 s69, s3, 0x10001
    v_mov_b32 v12, 0
    v_mov_b32 v13, 0
    v_mov_b32 v14, 0
    v_mov_b32 v15, 0
    v_and_b32 v2, 31, v1
    v_lshlrev_b32 v2, 4, v2
    ds_write_b128 v2, v[12:15] offset:51392
    ds_write_b128 v2, v[12:15] offset:51424
    s_lshl_b32 s70, s3, 2
    s_add_u32 s70, s70, 51648
    v_mov_b32 v28, s70
    v_mov_b32 v29, 1
    v_mov_b32 v95, 0
    v_mov_b32 v30, 51648
    s_lshl_b32 s70, s65, 6
    s_add_u32 s70, s70, s67
    s_lshl_b32 s70, s70, 10
    s_lshl_b32 s71, s66, 7
    s_add_u32 s70, s70, s71
    v_lshrrev_b32 v2, 3, v1
    v_and_b32 v3, 7, v1
    v_lshlrev_b32 v4, 12, v2
    v_lshl_add_u32 v4, v3, 4, v4
    v_add_u32 v4, s70, v4
    v_subrev_u32 v5, 1024, v4
    v_subrev_u32 v6, 2048, v4
    v_subrev_u32 v7, 3072, v4
    s_lshl_b32 s71, s66, 9
    v_lshl_add_u32 v8, v3, 6, s71
    s_lshl_b32 s72, s65, 6
    s_lshl_b32 s71, s66, 3
    s_add_u32 s72, s72, s71
    s_lshl_b32 s71, s67, 1
    s_add_u32 s72, s72, s71
    s_lshl_b32 s73, s72, 10
    v_lshlrev_b32 v9, 4, v1
    s_and_b32 s74, s3, 1
    s_mul_i32 s75, s74, 64
    s_mul_i32 s76, s74, 0
    s_add_u32 s76, s76, 128
    s_cmp_eq_u32 s68, 0
    s_cselect_b32 s75, s75, s76
    s_lshl_b32 s70, s64, 1
    s_add_u32 s70, s70, s69
    s_lshl_b32 s70, s70, 7
    s_add_u32 s70, s70, s75
    s_lshl_b32 s70, s70, 1
    v_lshl_add_u32 v11, v1, 1, s70
    s_waitcnt lgkmcnt(0)
    s_add_u32 s70, s2, s3
    s_cmp_lg_u32 s70, 0
    s_cbranch_scc1 K_nononce
    s_memrealtime s[70:71]
    s_mov_b32 s52, s38
    s_and_b32 s53, s39, 0xffff
    s_mov_b32 s54, 0x100
    s_mov_b32 s55, 0x00020000
    s_waitcnt lgkmcnt(0)
    s_or_b32 s70, s70, 1
    v_mov_b32 v100, s70
    v_mov_b32 v101, s71
    s_mov_b64 exec, 1
    buffer_store_dwordx2 v[100:101], v95, s[52:55], 0 offen sc1
    s_mov_b64 exec, -1
K_nononce:
    s_barrier
    s_cmp_eq_u32 s68, 0
    s_cbranch_scc1 K_noTL
    s_mov_b32 s48, s4
    s_and_b32 s49, s5, 0xffff
    s_mov_b32 s50, 0x200000
    s_mov_b32 s51, 0x00020000
    s_mov_b32 s70, 0x8000
    buffer_load_dwordx4 v[32:35], v4, s[48:51], 0 offen
    buffer_load_dwordx4 v[148:151], v4, s[48:51], s70 offen
    s_mov_b32 s56, s24
    s_and_b32 s57, s25, 0xffff
    s_mov_b32 s58, 0x200000
    s_mov_b32 s59, 0x00020000
    s_mov_b32 s60, s26
    s_and_b32 s61, s27, 0xffff
    s_mov_b32 s62, 0x200000
    s_mov_b32 s63, 0x00020000
    v_lshlrev_b32 v5, 10, v2
    v_lshl_add_u32 v5, v3, 4, v5
    s_lshl_b32 s71, s65, 6
    s_lshl_b32 s74, s67, 3
    s_add_u32 s71, s71, s74
    s_sub_u32 s71, s71, 8
    s_lshl_b32 s71, s71, 10
    s_lshl_b32 s74, s66, 7
    s_add_u32 s71, s71, s74
    v_add_u32 v5, s71, v5
    v_add_u32 v6, s70, v5
    v_add_u32 v7, s70, v6
    s_lshl_b32 s74, s67, 10
    s_add_u32 s74, s74, 125792
    s_mov_b32 m0, s74
    s_add_u32 s74, s74, 4096
    buffer_load_dwordx4 v5, s[56:59], 0 offen lds
    s_mov_b32 m0, s74
    s_add_u32 s74, s74, 4096
    buffer_load_dwordx4 v6, s[56:59], 0 offen lds
    s_cmp_lg_u32 s67, 0
    s_cbranch_scc1 K_nok3
    s_mov_b32 m0, s74
    s_nop 0
    buffer_load_dwordx4 v7, s[56:59], 0 offen lds
K_nok3:
    buffer_load_dwordx4 v[96:99], v4, s[60:63], 0 offen
    s_mov_b32 s44, s28
    s_and_b32 s45, s29, 0xffff
    s_mov_b32 s46, 0x1000
    s_mov_b32 s47, 0x00020000
    buffer_load_dwordx4 v[40:43], v8, s[44:47], 0 offen offset:0
    buffer_load_dwordx4 v[44:47], v8, s[44:47], 0 offen offset:16
    buffer_load_dwordx4 v[48:51], v8, s[44:47], 0 offen offset:32
    buffer_load_dwordx4 v[52:55], v8, s[44:47], 0 offen offset:48
    buffer_load_dwordx4 v[144:147], v4, s[60:63], s70 offen
    buffer_load_dwordx4 v[56:59], v9, s[48:51], s73 offen
    buffer_load_dwordx4 v[152:155], v9, s[48:51], s73 offen offset:1024
    s_mov_b32 s56, s34
    s_and_b32 s57, s35, 0xffff
    s_mov_b32 s58, 0x400
    s_mov_b32 s59, 0x00020000
    buffer_load_dwordx4 v[60:63], v9, s[56:59], 0 offen
    s_branch K_noPL
K_noTL:
    s_mov_b32 s56, s6
    s_and_b32 s57, s7, 0xffff
    s_mov_b32 s58, 0x20000
    s_mov_b32 s59, 0x00020000
    buffer_load_ushort v84, v11, s[56:59], 0 offen
    s_mov_b32 s60, s8
    s_and_b32 s61, s9, 0xffff
    s_mov_b32 s62, 0x20000
    s_mov_b32 s63, 0x00020000
    buffer_load_ushort v85, v11, s[60:63], 0 offen
    s_mov_b32 s56, s10
    s_and_b32 s57, s11, 0xffff
    s_mov_b32 s58, 0x20000
    s_mov_b32 s59, 0x00020000
    buffer_load_ushort v86, v11, s[56:59], 0 offen
    s_mov_b32 s60, s12
    s_and_b32 s61, s13, 0xffff
    s_mov_b32 s62, 0x20000
    s_mov_b32 s63, 0x00020000
    buffer_load_ushort v87, v11, s[60:63], 0 offen
    s_mov_b32 s56, s14
    s_and_b32 s57, s15, 0xffff
    s_mov_b32 s58, 0x20000
    s_mov_b32 s59, 0x00020000
    buffer_load_ushort v88, v11, s[56:59], 0 offen
    s_mov_b32 s60, s16
    s_and_b32 s61, s17, 0xffff
    s_mov_b32 s62, 0x20000
    s_mov_b32 s63, 0x00020000
    buffer_load_ushort v89, v11, s[60:63], 0 offen
K_noPL:
    s_mov_b32 s56, s30
    s_and_b32 s57, s31, 0xffff
    s_mov_b32 s58, 0x200000
    s_mov_b32 s59, 0x00020000
    s_lshl_b32 s74, s64, 2
    s_load_dword s22, s[18:19], s74
    s_load_dword s23, s[20:21], s74
    s_load_dword s42, s[32:33], s74
    s_mov_b32 s44, s40
    s_and_b32 s45, s41, 0xffff
    s_mov_b32 s46, 0x406000
    s_mov_b32 s47, 0x00020000
    s_mov_b32 s48, s36
    s_and_b32 s49, s37, 0xffff
    s_mov_b32 s50, 0x200000
    s_mov_b32 s51, 0x00020000
    s_mov_b32 s52, s38
    s_and_b32 s53, s39, 0xffff
    s_mov_b32 s54, 0x100
    s_mov_b32 s55, 0x00020000
    s_mov_b32 s43, 0xffff0000
    s_mov_b32 s5, 0
    s_and_b32 s61, s3, 1
    s_cmp_eq_u32 s68, 0
    s_cbranch_scc1 K_kgen
    s_mul_i32 s70, s3, 3072
    s_add_u32 s70, s70, 135008
    v_mul_u32_u24 v64, 144, v2
    v_lshl_add_u32 v64, v3, 4, v64
    v_add_u32 v64, s70, v64
    v_lshrrev_b32 v66, 4, v1
    v_bfe_u32 v68, v1, 2, 2
    v_and_b32 v69, 3, v1
    v_mul_u32_u24 v65, 144, v68
    v_lshl_add_u32 v65, v66, 5, v65
    v_lshl_add_u32 v65, v69, 3, v65
    v_add_u32 v65, s70, v65
    v_lshrrev_b32 v69, 3, v1
    v_lshlrev_b32 v69, 15, v69
    v_and_b32 v68, 7, v1
    v_lshl_add_u32 v69, v68, 4, v69
    s_lshl_b32 s70, s66, 18
    s_lshl_b32 s71, s65, 10
    s_add_u32 s70, s70, s71
    s_lshl_b32 s71, s67, 8
    s_add_u32 s70, s70, s71
    s_add_u32 s71, s70, 0x200000
    s_mov_b32 s62, 0
    s_mov_b32 s76, 0x00003f80
    s_mov_b32 s77, 0x3f800000
    s_mov_b32 s78, 0x0000ffff
    s_mov_b32 s79, 0x3f803f80
    v_and_b32 v224, 1, v1
    v_bfe_u32 v225, v1, 2, 2
    v_lshl_add_u32 v224, v224, 2, v225
    v_mul_u32_u24 v224, 1152, v224
    v_bfe_u32 v225, v1, 1, 1
    v_lshl_add_u32 v224, v225, 4, v224
    v_lshrrev_b32 v225, 4, v1
    v_lshl_add_u32 v224, v225, 5, v224
    s_lshl_b32 s74, s67, 8
    s_add_u32 s74, s74, 9344
    v_add_u32 v224, s74, v224
    v_lshrrev_b32 v233, 1, v1
    v_lshlrev_b32 v233, 7, v233
    v_and_b32 v225, 1, v1
    v_lshl_add_u32 v233, v225, 4, v233
    s_lshr_b32 s6, s64, 2
    s_lshl_b32 s6, s6, 15
    s_lshl_b32 s74, s67, 13
    s_add_u32 s6, s6, s74
    s_and_b32 s74, s64, 3
    s_lshl_b32 s74, s74, 5
    s_add_u32 s6, s6, s74
    s_add_u32 s6, s6, 0x200000
    s_add_u32 s13, s6, 4096
    s_lshl_b32 s74, s67, 11
    v_add_u32 v10, 43200, v9
    v_add_u32 v10, s74, v10
    s_add_u32 s60, s74, 4194304
    v_and_b32 v226, 31, v1
    v_lshlrev_b32 v226, 5, v226
    s_and_b32 s7, s2, 7
    s_lshl_b32 s7, s7, 10
    s_add_u32 s7, s7, 4202496
    v_and_b32 v227, 1, v1
    v_lshlrev_b32 v225, 3, v227
    v_lshlrev_b32 v227, 4, v227
    s_lshl_b32 s8, s65, 3
    s_add_u32 s8, s8, s66
    s_lshl_b32 s8, s8, 5
    s_add_u32 s8, s8, 4194304
    s_lshl_b32 s9, s66, 5
    s_add_u32 s9, s9, s65
    s_lshl_b32 s9, s9, 5
    s_add_u32 s9, s9, 4202496
    v_mov_b32 v100, 0
    v_mov_b32 v101, 0
    v_mov_b32 v102, 0
    v_mov_b32 v103, 0
    v_bfe_u32 v104, v1, 3, 2
    v_mul_u32_u24 v104, 1152, v104
    v_and_b32 v105, 7, v1
    v_lshl_add_u32 v104, v105, 4, v104
    s_mul_i32 s74, s67, 4608
    v_add_u32 v104, s74, v104
    ds_write_b128 v104, v[100:103]
    v_min_u32 v104, 11, v1
    v_lshrrev_b32 v105, 1, v104
    v_mul_u32_u24 v105, 4128, v105
    v_and_b32 v104, 1, v104
    v_lshl_add_u32 v104, v104, 4, v105
    ds_write_b128 v104, v[100:103] offset:18432
    s_mul_i32 s74, s67, 8208
    s_add_u32 s74, s74, 51936
    v_mov_b32 v104, s74
    ds_write_b128 v104, v[100:103]
    s_add_u32 s74, s74, 16
    v_lshl_add_u32 v230, v1, 4, s74
    s_mul_i32 s74, s67, 2064
    s_add_u32 s74, s74, 84768
    v_mov_b32 v105, s74
    ds_write_b128 v105, v[100:103]
    s_add_u32 s74, s74, 16
    v_lshl_add_u32 v231, v1, 2, s74
    v_and_b32 v4, 15, v1
    v_lshrrev_b32 v5, 4, v1
    v_lshlrev_b32 v6, 2, v4
    v_add_u32 v6, v6, v5
    s_lshl_b32 s74, s3, 1
    s_mul_i32 s74, s74, 1152
    s_add_u32 s74, s74, 8
    v_lshlrev_b32 v228, 3, v4
    v_lshl_add_u32 v228, v5, 4, v228
    v_add_u32 v228, s74, v228
    v_and_b32 v104, 3, v1
    v_bfe_u32 v105, v1, 2, 2
    v_sub_u32 v104, v104, v105
    v_lshlrev_b32 v104, 3, v104
    v_lshlrev_b32 v105, 6, v5
    v_sub_u32 v104, v104, v105
    s_add_u32 s74, s69, 4
    s_mul_i32 s74, s74, 4128
    s_add_u32 s74, s74, 18656
    v_add_u32 v229, s74, v104
    s_lshl_b32 s74, s3, 2
    s_add_u32 s74, s74, 51392
    v_mov_b32 v232, s74
    v_lshlrev_b32 v70, 9, v2
    v_lshl_add_u32 v70, v3, 4, v70
    s_lshl_b32 s74, s67, 7
    s_add_u32 s74, s74, 126432
    v_add_u32 v70, s74, v70
    s_waitcnt vmcnt(11)
    ds_write_b128 v64, v[32:35]
    ds_write_b128 v64, v[148:151] offset:1152
    s_waitcnt lgkmcnt(0)
    ds_read_b64_tr_b16 v[76:77], v65
    ds_read_b64_tr_b16 v[78:79], v65 offset:576
    ds_read_b64_tr_b16 v[80:81], v65 offset:1152
    ds_read_b64_tr_b16 v[82:83], v65 offset:1728
    s_waitcnt lgkmcnt(2)
    buffer_store_dwordx4 v[76:79], v69, s[44:47], s70 offen sc1
    s_waitcnt lgkmcnt(0)
    buffer_store_dwordx4 v[80:83], v69, s[44:47], s70 offen offset:128 sc1
    s_waitcnt vmcnt(11)
    ds_write_b32 v28, v29 offset:224
    s_waitcnt vmcnt(6)
K_tmask:
    v_and_b32 v160, s78, v40
    v_lshlrev_b32 v161, 16, v42
    v_and_b32 v162, s78, v44
    v_lshlrev_b32 v163, 16, v46
    v_and_b32 v164, s78, v48
    v_lshlrev_b32 v165, 16, v50
    v_and_b32 v166, s78, v52
    v_lshlrev_b32 v167, 16, v54
    v_lshrrev_b32 v168, 16, v40
    v_and_b32 v169, s43, v42
    v_lshrrev_b32 v170, 16, v44
    v_and_b32 v171, s43, v46
    v_lshrrev_b32 v172, 16, v48
    v_and_b32 v173, s43, v50
    v_lshrrev_b32 v174, 16, v52
    v_and_b32 v175, s43, v54
    v_and_b32 v176, s78, v41
    v_lshlrev_b32 v177, 16, v43
    v_and_b32 v178, s78, v45
    v_lshlrev_b32 v179, 16, v47
    v_and_b32 v180, s78, v49
    v_lshlrev_b32 v181, 16, v51
    v_and_b32 v182, s78, v53
    v_lshlrev_b32 v183, 16, v55
    v_lshrrev_b32 v184, 16, v41
    v_and_b32 v185, s43, v43
    v_lshrrev_b32 v186, 16, v45
    v_and_b32 v187, s43, v47
    v_lshrrev_b32 v188, 16, v49
    v_and_b32 v189, s43, v51
    v_lshrrev_b32 v190, 16, v53
    v_and_b32 v191, s43, v55
W1_p:
    ds_read_b128 v[72:75], v30 offset:240
    s_waitcnt lgkmcnt(0)
    v_and_b32 v72, v72, v73
    v_and_b32 v74, v74, v75
    v_and_b32 v72, v72, v74
    s_nop 0
    v_readfirstlane_b32 s4, v72
    s_cmp_eq_u32 s4, 1
    s_cbranch_scc1 W1_d
    s_sleep 1
    s_branch W1_p
W1_d:
K_tloop:
    ds_read_b128 v[12:15], v70 offset:384
    ds_read_b128 v[16:19], v70 offset:256
    ds_read_b128 v[20:23], v70 offset:128
    ds_read_b128 v[24:27], v70 offset:0
    v_add_u32 v70, 4096, v70
    s_waitcnt lgkmcnt(0)
    v_dot2_f32_bf16 v208, v12, v160, 0
    v_dot2_f32_bf16 v209, v12, v161, 0
    v_dot2_f32_bf16 v210, v13, v162, 0
    v_dot2_f32_bf16 v211, v13, v163, 0
    v_dot2_f32_bf16 v212, v14, v164, 0
    v_dot2_f32_bf16 v213, v14, v165, 0
    v_dot2_f32_bf16 v214, v15, v166, 0
    v_dot2_f32_bf16 v215, v15, v167, 0
    s_nop 0
    v_cvt_pk_bf16_f32 v192, v208, v209
    v_cvt_pk_bf16_f32 v193, v210, v211
    v_cvt_pk_bf16_f32 v194, v212, v213
    v_cvt_pk_bf16_f32 v195, v214, v215
    v_dot2_f32_bf16 v208, v16, v168, 0
    v_dot2_f32_bf16 v209, v16, v169, 0
    v_dot2_f32_bf16 v210, v17, v170, 0
    v_dot2_f32_bf16 v211, v17, v171, 0
    v_dot2_f32_bf16 v212, v18, v172, 0
    v_dot2_f32_bf16 v213, v18, v173, 0
    v_dot2_f32_bf16 v214, v19, v174, 0
    v_dot2_f32_bf16 v215, v19, v175, 0
    s_nop 0
    v_cvt_pk_bf16_f32 v196, v208, v209
    v_cvt_pk_bf16_f32 v197, v210, v211
    v_cvt_pk_bf16_f32 v198, v212, v213
    v_cvt_pk_bf16_f32 v199, v214, v215
    v_dot2_f32_bf16 v208, v20, v176, 0
    v_dot2_f32_bf16 v209, v20, v177, 0
    v_dot2_f32_bf16 v210, v21, v178, 0
    v_dot2_f32_bf16 v211, v21, v179, 0
    v_dot2_f32_bf16 v212, v22, v180, 0
    v_dot2_f32_bf16 v213, v22, v181, 0
    v_dot2_f32_bf16 v214, v23, v182, 0
    v_dot2_f32_bf16 v215, v23, v183, 0
    s_nop 0
    v_cvt_pk_bf16_f32 v200, v208, v209
    v_cvt_pk_bf16_f32 v201, v210, v211
    v_cvt_pk_bf16_f32 v202, v212, v213
    v_cvt_pk_bf16_f32 v203, v214, v215
    v_dot2_f32_bf16 v208, v24, v184, 0
    v_dot2_f32_bf16 v209, v24, v185, 0
    v_dot2_f32_bf16 v210, v25, v186, 0
    v_dot2_f32_bf16 v211, v25, v187, 0
    v_dot2_f32_bf16 v212, v26, v188, 0
    v_dot2_f32_bf16 v213, v26, v189, 0
    v_dot2_f32_bf16 v214, v27, v190, 0
    v_dot2_f32_bf16 v215, v27, v191, 0
    s_nop 0
    v_cvt_pk_bf16_f32 v204, v208, v209
    v_cvt_pk_bf16_f32 v205, v210, v211
    v_cvt_pk_bf16_f32 v206, v212, v213
    v_cvt_pk_bf16_f32 v207, v214, v215
    v_lshlrev_b32 v208, 16, v204
    v_and_b32 v209, s43, v204
    v_lshlrev_b32 v210, 16, v205
    v_and_b32 v211, s43, v205
    v_lshlrev_b32 v212, 16, v206
    v_and_b32 v213, s43, v206
    v_lshlrev_b32 v214, 16, v207
    v_and_b32 v215, s43, v207
    v_dot2_f32_bf16 v208, v200, s76, v208
    v_dot2_f32_bf16 v209, v200, s77, v209
    v_dot2_f32_bf16 v210, v201, s76, v210
    v_dot2_f32_bf16 v211, v201, s77, v211
    v_dot2_f32_bf16 v212, v202, s76, v212
    v_dot2_f32_bf16 v213, v202, s77, v213
    v_dot2_f32_bf16 v214, v203, s76, v214
    v_dot2_f32_bf16 v215, v203, s77, v215
    s_nop 0
    v_cvt_pk_bf16_f32 v204, v208, v209
    v_cvt_pk_bf16_f32 v205, v210, v211
    v_cvt_pk_bf16_f32 v206, v212, v213
    v_cvt_pk_bf16_f32 v207, v214, v215
    v_lshlrev_b32 v208, 16, v204
    v_and_b32 v209, s43, v204
    v_lshlrev_b32 v210, 16, v205
    v_and_b32 v211, s43, v205
    v_lshlrev_b32 v212, 16, v206
    v_and_b32 v213, s43, v206
    v_lshlrev_b32 v214, 16, v207
    v_and_b32 v215, s43, v207
    v_dot2_f32_bf16 v208, v196, s76, v208
    v_dot2_f32_bf16 v209, v196, s77, v209
    v_dot2_f32_bf16 v210, v197, s76, v210
    v_dot2_f32_bf16 v211, v197, s77, v211
    v_dot2_f32_bf16 v212, v198, s76, v212
    v_dot2_f32_bf16 v213, v198, s77, v213
    v_dot2_f32_bf16 v214, v199, s76, v214
    v_dot2_f32_bf16 v215, v199, s77, v215
    s_nop 0
    v_cvt_pk_bf16_f32 v204, v208, v209
    v_cvt_pk_bf16_f32 v205, v210, v211
    v_cvt_pk_bf16_f32 v206, v212, v213
    v_cvt_pk_bf16_f32 v207, v214, v215
    v_lshlrev_b32 v208, 16, v204
    v_and_b32 v209, s43, v204
    v_lshlrev_b32 v210, 16, v205
    v_and_b32 v211, s43, v205
    v_lshlrev_b32 v212, 16, v206
    v_and_b32 v213, s43, v206
    v_lshlrev_b32 v214, 16, v207
    v_and_b32 v215, s43, v207
    v_dot2_f32_bf16 v208, v192, s76, v208
    v_dot2_f32_bf16 v209, v192, s77, v209
    v_dot2_f32_bf16 v210, v193, s76, v210
    v_dot2_f32_bf16 v211, v193, s77, v211
    v_dot2_f32_bf16 v212, v194, s76, v212
    v_dot2_f32_bf16 v213, v194, s77, v213
    v_dot2_f32_bf16 v214, v195, s76, v214
    v_dot2_f32_bf16 v215, v195, s77, v215
    s_nop 0
    v_cvt_pk_bf16_f32 v204, v208, v209
    v_cvt_pk_bf16_f32 v205, v210, v211
    v_cvt_pk_bf16_f32 v206, v212, v213
    v_cvt_pk_bf16_f32 v207, v214, v215
    v_and_b32 v216, s78, v96
    v_and_b32 v217, s43, v96
    v_and_b32 v218, s78, v97
    v_and_b32 v219, s43, v97
    v_and_b32 v220, s78, v98
    v_and_b32 v221, s43, v98
    v_and_b32 v222, s78, v99
    v_and_b32 v223, s43, v99
    v_dot2_f32_bf16 v208, v204, v216, 0
    v_dot2_f32_bf16 v209, v204, v217, 0
    v_dot2_f32_bf16 v210, v205, v218, 0
    v_dot2_f32_bf16 v211, v205, v219, 0
    v_dot2_f32_bf16 v212, v206, v220, 0
    v_dot2_f32_bf16 v213, v206, v221, 0
    v_dot2_f32_bf16 v214, v207, v222, 0
    v_dot2_f32_bf16 v215, v207, v223, 0
    s_nop 0
    v_cvt_pk_bf16_f32 v36, v208, v209
    v_cvt_pk_bf16_f32 v37, v210, v211
    v_cvt_pk_bf16_f32 v38, v212, v213
    v_cvt_pk_bf16_f32 v39, v214, v215
    ds_write_b128 v64, v[36:39]
    s_waitcnt lgkmcnt(0)
    ds_read_b64_tr_b16 v[76:77], v65
    ds_read_b64_tr_b16 v[78:79], v65 offset:576
    s_waitcnt lgkmcnt(0)
    buffer_store_dwordx4 v[76:79], v69, s[44:47], s71 offen sc1
    s_cmp_eq_u32 s62, 1
    s_cbranch_scc1 K_tdone
    s_mov_b32 s62, 1
    s_add_u32 s71, s71, 128
    s_waitcnt vmcnt(6)
    v_mov_b32 v96, v144
    v_mov_b32 v97, v145
    v_mov_b32 v98, v146
    v_mov_b32 v99, v147
    s_branch K_tloop
K_tdone:
    s_waitcnt vmcnt(2)
    ds_write_b32 v28, v29 offset:64
K_nwait:
    ds_read_b64 v[92:93], v30 offset:272
    s_waitcnt lgkmcnt(0)
    v_readfirstlane_b32 s56, v92
    v_readfirstlane_b32 s57, v93
    s_cmp_lg_u32 s56, 0
    s_cbranch_scc1 K_nok
    s_sleep 1
    s_branch K_nwait
K_nok:
    s_cmp_lg_u32 s3, 6
    s_cbranch_scc1 K_nopubU
W2_p:
    ds_read_b128 v[144:147], v30 offset:80
    s_waitcnt lgkmcnt(0)
    v_and_b32 v144, v144, v145
    v_and_b32 v146, v146, v147
    v_and_b32 v144, v144, v146
    s_nop 0
    v_readfirstlane_b32 s4, v144
    s_cmp_eq_u32 s4, 1
    s_cbranch_scc1 W2_d
    s_sleep 1
    s_branch W2_p
W2_d:
    s_add_u32 s70, s9, 8192
    s_mov_b64 exec, 1
    buffer_store_dwordx2 v[92:93], v227, s[44:47], s70 offen sc1
    s_mov_b64 exec, -1
K_nopubU:
    s_mov_b32 s62, 0
K_gmask:
    v_and_b32 v216, s78, v60
    v_and_b32 v217, s43, v60
    v_and_b32 v218, s78, v61
    v_and_b32 v219, s43, v61
    v_and_b32 v220, s78, v62
    v_and_b32 v221, s43, v62
    v_and_b32 v222, s78, v63
    v_and_b32 v223, s43, v63
K_gloop:
    v_dot2_f32_bf16 v208, v56, v216, 0
    v_dot2_f32_bf16 v209, v56, v217, 0
    v_dot2_f32_bf16 v210, v57, v218, 0
    v_dot2_f32_bf16 v211, v57, v219, 0
    v_dot2_f32_bf16 v212, v58, v220, 0
    v_dot2_f32_bf16 v213, v58, v221, 0
    v_dot2_f32_bf16 v214, v59, v222, 0
    v_dot2_f32_bf16 v215, v59, v223, 0
    s_nop 0
    v_cvt_pk_bf16_f32 v192, v208, v209
    v_cvt_pk_bf16_f32 v193, v210, v211
    v_cvt_pk_bf16_f32 v194, v212, v213
    v_cvt_pk_bf16_f32 v195, v214, v215
    v_dot2_f32_bf16 v208, v192, s79, 0
    v_dot2_f32_bf16 v209, v193, s79, 0
    v_dot2_f32_bf16 v210, v194, s79, 0
    v_dot2_f32_bf16 v211, v195, s79, 0
    s_nop 2
    v_add_f32 v208, v208, v209
    v_add_f32 v210, v210, v211
    v_add_f32 v74, v208, v210
    s_nop 1
    v_add_f32_dpp v74, v74, v74 row_shr:1 row_mask:0xf bank_mask:0xf bound_ctrl:0
    s_nop 1
    v_add_f32_dpp v74, v74, v74 row_shr:2 row_mask:0xf bank_mask:0xf bound_ctrl:0
    s_nop 1
    v_add_f32_dpp v74, v74, v74 row_shr:4 row_mask:0xf bank_mask:0xf bound_ctrl:0
    s_nop 1
    v_add_f32_dpp v74, v74, v74 row_shr:8 row_mask:0xf bank_mask:0xf bound_ctrl:0
    s_nop 1
    v_add_f32_dpp v74, v74, v74 row_bcast:15 row_mask:0xa bank_mask:0xf
    s_nop 1
    v_add_f32_dpp v74, v74, v74 row_bcast:31 row_mask:0xc bank_mask:0xf
    s_nop 1
    v_cvt_pk_bf16_f32 v74, v74, v74
    v_lshlrev_b32 v74, 16, v74
    v_mul_f32 v74, 0xbfb8aa3b, v74
    v_exp_f32 v74, v74
    s_nop 0
    v_add_f32 v74, 1.0, v74
    v_rcp_f32 v74, v74
    s_nop 0
    v_cvt_pk_bf16_f32 v74, v74, v74
    s_lshl_b32 s72, s67, 1
    s_add_u32 s72, s72, s62
    s_lshl_b32 s72, s72, 1
    s_add_u32 s72, s72, 51904
    v_mov_b32 v75, s72
    v_cmp_eq_u32 vcc, 63, v1
    s_and_saveexec_b64 s[74:75], vcc
    ds_write_b16 v75, v74
    s_mov_b64 exec, s[74:75]
    s_cmp_eq_u32 s62, 1
    s_cbranch_scc1 K_bwave
    s_mov_b32 s62, 1
    v_mov_b32 v56, v152
    v_mov_b32 v57, v153
    v_mov_b32 v58, v154
    v_mov_b32 v59, v155
    s_branch K_gloop
K_kgen:
    s_setprio 2
    v_and_b32 v20, 15, v1
    v_lshrrev_b32 v21, 4, v1
    s_mov_b32 s74, 0x00040000
    s_mov_b32 s75, 0x02000100
    s_mov_b32 s76, 0x00010001
    s_mov_b32 s77, 0x00040002
    s_mov_b32 s78, 0x00020002
    s_mov_b32 s79, 0x01000004
    v_lshrrev_b32 v22, 2, v20
    v_lshlrev_b32 v22, 4, v22
    v_lshrrev_b64 v[32:33], v22, s[74:75]
    v_and_b32 v32, 0xffff, v32
    v_lshrrev_b64 v[34:35], v22, s[76:77]
    v_and_b32 v34, 0xffff, v34
    v_and_b32 v23, 1, v20
    v_mad_u32_u24 v32, v23, v34, v32
    v_lshrrev_b64 v[34:35], v22, s[78:79]
    v_and_b32 v34, 0xffff, v34
    v_bfe_u32 v23, v20, 1, 1
    v_mad_u32_u24 v32, v23, v34, v32
    v_cvt_f32_u32 v24, v32
    v_lshrrev_b32 v33, 7, v32
    v_and_b32 v32, 127, v32
    v_cvt_f32_u32 v16, v33
    v_cvt_f32_u32 v17, v32
    v_add_u32 v32, 8, v20
    v_cvt_f32_u32 v18, v32
    v_mul_f32 v26, 0x43000000, v18
    v_lshlrev_b32 v22, 3, v20
    v_cvt_f32_u32 v27, v22
    s_waitcnt lgkmcnt(0)
    s_lshl_b32 s70, s22, 16
    s_and_b32 s22, s22, s43
    s_cmp_eq_u32 s69, 0
    s_cselect_b32 s22, s70, s22
    v_mov_b32 v40, 0x3fb8aa3b
    v_mul_f32 v41, s22, v40
    v_exp_f32 v41, v41
    s_nop 0
    v_cvt_pk_bf16_f32 v41, v41, v41
    v_lshlrev_b32 v41, 16, v41
    s_waitcnt vmcnt(0)
K_dA:
    v_lshlrev_b32 v84, 16, v84
    v_lshlrev_b32 v85, 16, v85
    v_lshlrev_b32 v86, 16, v86
    v_lshlrev_b32 v87, 16, v87
    v_lshlrev_b32 v88, 16, v88
    v_lshlrev_b32 v89, 16, v89
    v_mul_f32 v84, v41, v84
    v_mul_f32 v85, v41, v85
    v_mul_f32 v86, v41, v86
    v_mul_f32 v87, v41, v87
    v_mul_f32 v44, v40, v84
    v_mul_f32 v45, 0.15915494, v85
    v_rndne_f32 v46, v45
    v_sub_f32 v45, v45, v46
    v_mul_f32 v46, 0x43000000, v45
    v_rndne_f32 v47, v46
    v_sub_f32 v46, v46, v47
    v_mul_f32 v84, 0x43000000, v44
    v_exp_f32 v84, v84
    v_cos_f32 v47, v46
    v_sin_f32 v85, v46
    v_mul_f32 v80, v88, v86
    v_fma_f32 v80, -v89, v87, v80
    v_mul_f32 v81, v88, v87
    v_fma_f32 v81, v89, v86, v81
    v_mul_f32 v47, v84, v47
    v_mul_f32 v82, v84, v85
    s_lshl_b32 s70, s3, 11
    s_add_u32 s70, s70, 117600
    v_lshl_add_u32 v42, v1, 5, s70
    ds_write_b128 v42, v[44:47]
    ds_write_b128 v42, v[80:83] offset:16
    v_lshl_add_u32 v43, v21, 6, s70
    v_mov_b32 v48, 0
    v_mov_b32 v49, 0
    v_mov_b32 v50, 0
    v_mov_b32 v51, 0
    v_mov_b32 v52, 0
    v_mov_b32 v53, 0
    v_mov_b32 v54, 0
    v_mov_b32 v55, 0
    v_mov_b32 v56, 0
    v_mov_b32 v57, 0
    v_mov_b32 v58, 0
    v_mov_b32 v59, 0
    s_waitcnt lgkmcnt(0)
    ds_read_b128 v[60:63], v43 offset:0
    ds_read_b128 v[64:67], v43 offset:16
    ds_read_b128 v[68:71], v43 offset:32
    ds_read_b128 v[72:75], v43 offset:48
    s_mov_b32 s62, 0
    s_mov_b32 s63, 8
K_loop:
    s_waitcnt lgkmcnt(0)
    v_mul_f32 v108, v60, v27
    v_mul_f32 v109, v61, v27
    v_mul_f32 v96, v60, v24
    v_mul_f32 v97, v61, v17
    v_mul_f32 v104, v60, v26
    v_mul_f32 v105, v62, v18
    v_fma_f32 v97, v62, v16, v97
    v_mov_b32 v76, v63
    v_mov_b32 v77, v64
    v_mov_b32 v78, v65
    v_mov_b32 v79, v66
    v_mul_f32 v148, v68, v27
    v_mul_f32 v149, v69, v27
    v_mul_f32 v136, v68, v24
    v_mul_f32 v137, v69, v17
    v_mul_f32 v144, v68, v26
    v_mul_f32 v145, v70, v18
    v_fma_f32 v137, v70, v16, v137
    v_mov_b32 v80, v71
    v_mov_b32 v81, v72
    v_mov_b32 v82, v73
    v_mov_b32 v83, v74
    v_add_u32 v43, 256, v43
    ds_read_b128 v[60:63], v43 offset:0
    ds_read_b128 v[64:67], v43 offset:16
    ds_read_b128 v[68:71], v43 offset:32
    ds_read_b128 v[72:75], v43 offset:48
    v_exp_f32 v108, v108
    v_cos_f32 v110, v109
    v_sin_f32 v111, v109
    v_exp_f32 v96, v96
    v_cos_f32 v98, v97
    v_sin_f32 v99, v97
    v_exp_f32 v104, v104
    v_cos_f32 v106, v105
    v_sin_f32 v107, v105
    v_mul_f32 v110, v108, v110
    v_mul_f32 v111, v108, v111
    v_mul_f32 v108, v77, v110
    v_mul_f32 v109, v77, v111
    v_fma_f32 v108, -v78, v111, v108
    v_fma_f32 v111, -v78, v110, -v109
    v_mov_b32 v110, v108
    v_mul_f32 v98, v96, v98
    v_mul_f32 v99, v96, v99
    v_mul_f32 v106, v104, v106
    v_mul_f32 v107, v104, v107
    v_mul_f32 v102, v98, v76
    v_mul_f32 v103, v98, v79
    v_fma_f32 v102, -v99, v79, v102
    v_fma_f32 v103, v99, v76, v103
    v_cvt_pk_bf16_f32 v112, v98, v99
    v_lshlrev_b32 v96, 16, v112
    v_and_b32 v97, s43, v112
    v_sub_f32 v96, v98, v96
    v_sub_f32 v97, v99, v97
    v_cvt_pk_bf16_f32 v118, v96, v97
    v_cvt_pk_bf16_f32 v114, v102, v103
    v_lshlrev_b32 v100, 16, v114
    v_and_b32 v101, s43, v114
    v_sub_f32 v100, v102, v100
    v_sub_f32 v101, v103, v101
    v_cvt_pk_bf16_f32 v120, v100, v101
    v_cvt_pk_bf16_f32 v116, v106, v107
    v_lshlrev_b32 v104, 16, v116
    v_and_b32 v105, s43, v116
    v_sub_f32 v104, v106, v104
    v_sub_f32 v105, v107, v105
    v_cvt_pk_bf16_f32 v122, v104, v105
    v_cvt_pk_bf16_f32 v124, v110, v111
    v_lshlrev_b32 v108, 16, v124
    v_and_b32 v109, s43, v124
    v_sub_f32 v108, v110, v108
    v_sub_f32 v109, v111, v109
    v_cvt_pk_bf16_f32 v126, v108, v109
    v_exp_f32 v148, v148
    v_cos_f32 v150, v149
    v_sin_f32 v151, v149
    v_exp_f32 v136, v136
    v_cos_f32 v138, v137
    v_sin_f32 v139, v137
    v_exp_f32 v144, v144
    v_cos_f32 v146, v145
    v_sin_f32 v147, v145
    v_mul_f32 v150, v148, v150
    v_mul_f32 v151, v148, v151
    v_mul_f32 v148, v81, v150
    v_mul_f32 v149, v81, v151
    v_fma_f32 v148, -v82, v151, v148
    v_fma_f32 v151, -v82, v150, -v149
    v_mov_b32 v150, v148
    v_mul_f32 v138, v136, v138
    v_mul_f32 v139, v136, v139
    v_mul_f32 v146, v144, v146
    v_mul_f32 v147, v144, v147
    v_mul_f32 v142, v138, v80
    v_mul_f32 v143, v138, v83
    v_fma_f32 v142, -v139, v83, v142
    v_fma_f32 v143, v139, v80, v143
    v_cvt_pk_bf16_f32 v113, v138, v139
    v_lshlrev_b32 v136, 16, v113
    v_and_b32 v137, s43, v113
    v_sub_f32 v136, v138, v136
    v_sub_f32 v137, v139, v137
    v_cvt_pk_bf16_f32 v119, v136, v137
    v_cvt_pk_bf16_f32 v115, v142, v143
    v_lshlrev_b32 v140, 16, v115
    v_and_b32 v141, s43, v115
    v_sub_f32 v140, v142, v140
    v_sub_f32 v141, v143, v141
    v_cvt_pk_bf16_f32 v121, v140, v141
    v_cvt_pk_bf16_f32 v117, v146, v147
    v_lshlrev_b32 v144, 16, v117
    v_and_b32 v145, s43, v117
    v_sub_f32 v144, v146, v144
    v_sub_f32 v145, v147, v145
    v_cvt_pk_bf16_f32 v123, v144, v145
    v_cvt_pk_bf16_f32 v125, v150, v151
    v_lshlrev_b32 v148, 16, v125
    v_and_b32 v149, s43, v125
    v_sub_f32 v148, v150, v148
    v_sub_f32 v149, v151, v149
    v_cvt_pk_bf16_f32 v127, v148, v149
    s_add_u32 s62, s62, 1
    s_cmp_eq_u32 s62, 3
    v_mfma_f32_16x16x16_bf16 v[48:51], v[112:113], v[124:125], v[48:51]
    v_mfma_f32_16x16x16_bf16 v[48:51], v[112:113], v[126:127], v[48:51]
    v_mfma_f32_16x16x16_bf16 v[48:51], v[118:119], v[124:125], v[48:51]
    v_mfma_f32_16x16x16_bf16 v[52:55], v[114:115], v[124:125], v[52:55]
    v_mfma_f32_16x16x16_bf16 v[52:55], v[114:115], v[126:127], v[52:55]
    v_mfma_f32_16x16x16_bf16 v[52:55], v[120:121], v[124:125], v[52:55]
    v_mfma_f32_16x16x16_bf16 v[56:59], v[116:117], v[124:125], v[56:59]
    v_mfma_f32_16x16x16_bf16 v[56:59], v[116:117], v[126:127], v[56:59]
    v_mfma_f32_16x16x16_bf16 v[56:59], v[122:123], v[124:125], v[56:59]
    s_cbranch_scc0 K_nost
    s_lshl_b32 s70, s64, 13
    s_lshl_b32 s71, s3, 11
    s_add_u32 s70, s70, s71
    s_mul_i32 s71, s69, 4128
    s_lshl_b32 s72, s61, 11
    s_add_u32 s71, s71, s72
    s_add_u32 s71, s71, 34976
    s_mov_b32 m0, s71
    s_nop 0
    buffer_load_dwordx4 v9, s[56:59], s70 offen lds
    buffer_load_dwordx4 v9, s[56:59], s70 offen offset:1024 lds
K_nost:
    s_cmp_lg_u32 s3, 0
    s_cbranch_scc1 K_non
    s_cmp_eq_u32 s62, 1
    s_cbranch_scc0 K_non1
    buffer_load_dwordx2 v[92:93], v95, s[52:55], 0 offen sc1
K_non1:
    s_cmp_eq_u32 s62, 2
    s_cbranch_scc0 K_non
    s_mov_b32 s70, 0
K_npoll:
    s_waitcnt vmcnt(0)
    v_readfirstlane_b32 s71, v92
    s_add_u32 s70, s70, 1
    s_cmp_lg_u32 s71, 0
    s_cbranch_scc1 K_ngot
    s_sleep 4
    buffer_load_dwordx2 v[92:93], v95, s[52:55], 0 offen sc1
    s_cmp_lt_u32 s70, 0x40000
    s_cbranch_scc1 K_npoll
    s_waitcnt vmcnt(0)
    v_mov_b32 v92, 1
K_ngot:
    ds_write_b64 v30, v[92:93] offset:272
K_non:
    s_cmp_eq_u32 s62, 6
    s_cbranch_scc0 K_nost2
    s_waitcnt vmcnt(0)
    ds_write_b32 v28, v29 offset:0
K_nost2:
    s_cmp_lt_u32 s62, s63
    s_cbranch_scc1 K_loop
    s_waitcnt lgkmcnt(0)
    s_mul_i32 s70, s3, 3072
    s_add_u32 s70, s70, 135008
    v_lshl_add_u32 v39, v1, 4, s70
    v_and_b32 v4, 15, v1
    v_lshrrev_b32 v5, 4, v1
    v_lshlrev_b32 v6, 2, v4
    v_add_u32 v6, v6, v5
    s_nop 1
    ds_write_b128 v39, v[48:51] offset:0
    ds_write_b128 v39, v[52:55] offset:1024
    ds_write_b128 v39, v[56:59] offset:2048
    ds_write_b32 v28, v29 offset:32
    s_mul_i32 s70, s69, 12288
    s_add_u32 s70, s70, 93024
    v_lshlrev_b32 v32, 5, v20
    v_add_u32 v32, s70, v32
    v_lshl_add_u32 v44, v21, 11, v32
    v_add_u32 v44, 4096, v44
    v_add_u32 v45, 512, v44
    v_add_u32 v46, 1024, v44
    v_add_u32 v47, 1536, v44
    v_lshlrev_b32 v22, 4, v21
    v_lshrrev_b64 v[60:61], v22, s[74:75]
    v_and_b32 v60, 0xffff, v60
    v_lshl_add_u32 v35, v60, 2, v32
    s_lshl_b32 s71, s61, 9
    v_add_u32 v35, s71, v35
    v_lshrrev_b64 v[60:61], v22, s[76:77]
    v_and_b32 v60, 0xffff, v60
    v_lshl_add_u32 v36, v60, 2, v35
    v_lshrrev_b64 v[62:63], v22, s[78:79]
    v_and_b32 v62, 0xffff, v62
    v_lshl_add_u32 v37, v62, 2, v35
    v_lshl_add_u32 v38, v62, 2, v36
    s_mul_i32 s70, s69, 6144
    s_add_u32 s70, s70, 135008
    v_lshl_add_u32 v39, v1, 4, s70
    s_lshl_b32 s71, s61, 10
    v_add_u32 v40, s71, v39
    s_lshl_b32 s71, s61, 9
    v_lshl_add_u32 v60, v1, 3, s71
    s_mul_i32 s70, s69, 12288
    s_add_u32 s70, s70, 93024
    v_lshl_add_u32 v72, v60, 2, s70
    v_and_b32 v73, 1, v1
    v_mul_u32_u24 v73, 0x202, v73
    v_add_u32 v73, 0x03020100, v73
    v_add_u32 v62, 0, v60
    v_add_u32 v63, 1, v60
    v_cvt_f32_u32 v62, v62
    v_cvt_f32_u32 v63, v63
    v_cvt_pk_bf16_f32 v62, v62, v63
    v_and_b32 v63, s43, v62
    v_lshlrev_b32 v62, 16, v62
    v_cvt_u32_f32 v62, v62
    v_cvt_u32_f32 v63, v63
    v_lshl_add_u32 v64, v62, 2, s70
    v_lshl_add_u32 v65, v63, 2, s70
    v_add_u32 v62, 2, v60
    v_add_u32 v63, 3, v60
    v_cvt_f32_u32 v62, v62
    v_cvt_f32_u32 v63, v63
    v_cvt_pk_bf16_f32 v62, v62, v63
    v_and_b32 v63, s43, v62
    v_lshlrev_b32 v62, 16, v62
    v_cvt_u32_f32 v62, v62
    v_cvt_u32_f32 v63, v63
    v_lshl_add_u32 v66, v62, 2, s70
    v_lshl_add_u32 v67, v63, 2, s70
    v_add_u32 v62, 4, v60
    v_add_u32 v63, 5, v60
    v_cvt_f32_u32 v62, v62
    v_cvt_f32_u32 v63, v63
    v_cvt_pk_bf16_f32 v62, v62, v63
    v_and_b32 v63, s43, v62
    v_lshlrev_b32 v62, 16, v62
    v_cvt_u32_f32 v62, v62
    v_cvt_u32_f32 v63, v63
    v_lshl_add_u32 v68, v62, 2, s70
    v_lshl_add_u32 v69, v63, 2, s70
    v_add_u32 v62, 6, v60
    v_add_u32 v63, 7, v60
    v_cvt_f32_u32 v62, v62
    v_cvt_f32_u32 v63, v63
    v_cvt_pk_bf16_f32 v62, v62, v63
    v_and_b32 v63, s43, v62
    v_lshlrev_b32 v62, 16, v62
    v_cvt_u32_f32 v62, v62
    v_cvt_u32_f32 v63, v63
    v_lshl_add_u32 v70, v62, 2, s70
    v_lshl_add_u32 v71, v63, 2, s70
    s_mul_i32 s70, s69, 4128
    s_add_u32 s70, s70, 18464
    v_lshl_add_u32 v61, v60, 1, s70
W3_p:
    ds_read_b128 v[96:99], v30 offset:32
    s_waitcnt lgkmcnt(0)
    v_and_b32 v96, v96, v97
    v_and_b32 v98, v98, v99
    v_and_b32 v96, v96, v98
    s_nop 0
    v_readfirstlane_b32 s4, v96
    s_cmp_eq_u32 s4, 1
    s_cbranch_scc1 W3_d
    s_sleep 1
    s_branch W3_p
W3_d:
    ds_read_b128 v[96:99], v40 offset:0
    ds_read_b128 v[100:103], v40 offset:3072
    ds_read_b128 v[112:115], v39 offset:2048
    ds_read_b128 v[116:119], v39 offset:5120
    s_waitcnt lgkmcnt(2)
    v_add_f32 v96, v96, v100
    v_add_f32 v97, v97, v101
    v_add_f32 v98, v98, v102
    v_add_f32 v99, v99, v103
    s_waitcnt lgkmcnt(0)
    v_add_f32 v112, v112, v116
    v_add_f32 v113, v113, v117
    v_add_f32 v114, v114, v118
    v_add_f32 v115, v115, v119
    ds_write_b32 v35, v96
    ds_write_b32 v36, v97
    ds_write_b32 v37, v98
    ds_write_b32 v38, v99
    ds_write_b32 v44, v112
    ds_write_b32 v45, v113
    ds_write_b32 v46, v114
    ds_write_b32 v47, v115
    ds_write_b32 v28, v29 offset:64
W4_p:
    ds_read_b128 v[96:99], v30 offset:64
    s_waitcnt lgkmcnt(0)
    v_and_b32 v96, v96, v97
    v_and_b32 v98, v98, v99
    v_and_b32 v96, v96, v98
    s_nop 0
    v_readfirstlane_b32 s4, v96
    s_cmp_eq_u32 s4, 1
    s_cbranch_scc1 W4_d
    s_sleep 1
    s_branch W4_p
W4_d:
    ds_read_b32 v104, v72 offset:4096
    ds_read_b32 v105, v72 offset:4128
    ds_read_b32 v96, v64
    ds_read_b32 v97, v65
    ds_read_b32 v98, v66
    ds_read_b32 v99, v67
    ds_read_b32 v100, v68
    ds_read_b32 v101, v69
    ds_read_b32 v102, v70
    ds_read_b32 v103, v71
    s_mov_b32 s70, 0x01000100
    s_mov_b32 s71, 0x03020302
    s_waitcnt lgkmcnt(8)
    v_cvt_pk_bf16_f32 v106, v104, v105
    v_lshlrev_b32 v62, 16, v106
    v_and_b32 v63, s43, v106
    v_sub_f32 v62, v104, v62
    v_sub_f32 v63, v105, v63
    v_cvt_pk_bf16_f32 v107, v62, v63
    v_perm_b32 v120, v106, v106, s70
    v_perm_b32 v122, v106, v106, v73
    v_perm_b32 v123, v106, v106, s71
    v_mov_b32 v121, v120
    v_perm_b32 v124, v107, v107, s70
    v_perm_b32 v126, v107, v107, v73
    v_perm_b32 v127, v107, v107, s71
    v_mov_b32 v125, v124
    s_waitcnt lgkmcnt(6)
    v_cvt_pk_bf16_f32 v112, v96, v97
    v_lshlrev_b32 v62, 16, v112
    v_and_b32 v63, s43, v112
    v_sub_f32 v62, v96, v62
    v_sub_f32 v63, v97, v63
    v_cvt_pk_bf16_f32 v116, v62, v63
    s_waitcnt lgkmcnt(4)
    v_cvt_pk_bf16_f32 v113, v98, v99
    v_lshlrev_b32 v62, 16, v113
    v_and_b32 v63, s43, v113
    v_sub_f32 v62, v98, v62
    v_sub_f32 v63, v99, v63
    v_cvt_pk_bf16_f32 v117, v62, v63
    s_waitcnt lgkmcnt(2)
    v_cvt_pk_bf16_f32 v114, v100, v101
    v_lshlrev_b32 v62, 16, v114
    v_and_b32 v63, s43, v114
    v_sub_f32 v62, v100, v62
    v_sub_f32 v63, v101, v63
    v_cvt_pk_bf16_f32 v118, v62, v63
    s_waitcnt lgkmcnt(0)
    v_cvt_pk_bf16_f32 v115, v102, v103
    v_lshlrev_b32 v62, 16, v115
    v_and_b32 v63, s43, v115
    v_sub_f32 v62, v102, v62
    v_sub_f32 v63, v103, v63
    v_cvt_pk_bf16_f32 v119, v62, v63
    ds_write_b128 v61, v[112:115] offset:0
    ds_write_b128 v61, v[116:119] offset:8256
    ds_write_b128 v61, v[120:123] offset:2048
    ds_write_b128 v61, v[124:127] offset:10304
    ds_write_b32 v28, v29 offset:96
    s_branch K_csetup
K_bwave:
    ds_write_b32 v28, v29 offset:32
    s_sub_u32 s14, s6, 0x200000
    s_sub_u32 s15, s13, 0x200000
    s_add_u32 s12, s7, 8192
    s_cmp_lg_u32 s3, 4
    s_cbranch_scc1 K_b1
    buffer_load_dwordx2 v[112:113], v226, s[44:47], s12 offen sc1
    s_waitcnt vmcnt(1)
    ds_write_b32 v28, v29 offset:0
W5_p:
    ds_read_b128 v[144:147], v30 offset:16
    s_waitcnt lgkmcnt(0)
    v_and_b32 v144, v144, v145
    v_and_b32 v146, v146, v147
    v_and_b32 v144, v144, v146
    s_nop 0
    v_readfirstlane_b32 s4, v144
    s_cmp_eq_u32 s4, 1
    s_cbranch_scc1 W5_d
    s_sleep 1
    s_branch W5_p
W5_d:
    s_mov_b64 exec, 1
    buffer_store_dwordx2 v[92:93], v227, s[44:47], s9 offen sc1
    s_mov_b64 exec, -1
    s_mov_b32 s70, 0
    s_waitcnt vmcnt(1)
    s_branch K_upoll1
K_b1:
    s_cmp_lg_u32 s3, 6
    s_cbranch_scc1 K_b2
    s_waitcnt vmcnt(1)
    s_branch K_b3
K_b2:
    s_waitcnt vmcnt(0)
K_b3:
    ds_write_b32 v28, v29 offset:0
    s_cmp_lg_u32 s3, 5
    s_cbranch_scc1 K_uwait
W6_p:
    ds_read_b128 v[144:147], v30 offset:48
    s_waitcnt lgkmcnt(0)
    v_and_b32 v144, v144, v145
    v_and_b32 v146, v146, v147
    v_and_b32 v144, v144, v146
    s_nop 0
    v_readfirstlane_b32 s4, v144
    s_cmp_eq_u32 s4, 1
    s_cbranch_scc1 W6_d
    s_sleep 1
    s_branch W6_p
W6_d:
    ds_read_b64 v[144:145], v225 offset:51904
    v_mov_b32 v146, s56
    v_mov_b32 v147, s57
    s_waitcnt lgkmcnt(0)
    s_mov_b64 exec, 3
    buffer_store_dwordx4 v[144:147], v227, s[44:47], s8 offen sc1
    s_mov_b64 exec, -1
    s_branch K_uwait
K_upoll:
    buffer_load_dwordx2 v[112:113], v226, s[44:47], s12 offen sc1
    s_waitcnt vmcnt(0)
K_upoll1:
    v_xor_b32 v112, s56, v112
    v_xor_b32 v113, s57, v113
    v_or_b32 v112, v112, v113
    v_cmp_ne_u32 vcc, 0, v112
    s_add_u32 s70, s70, 1
    s_cmp_eq_u64 vcc, 0
    s_cbranch_scc1 K_uok
    s_sleep 8
    s_cmp_lt_u32 s70, 0x40000
    s_cbranch_scc1 K_upoll
K_uok:
    ds_write_b32 v28, v29 offset:96
    s_branch K_udone
K_uwait:
    ds_read_b32 v93, v30 offset:112
    s_waitcnt lgkmcnt(0)
    v_readfirstlane_b32 s70, v93
    s_cmp_eq_u32 s70, 1
    s_cbranch_scc1 K_udone
    s_sleep 1
    s_branch K_uwait
K_udone:
    buffer_load_dwordx4 v[192:195], v233, s[44:47], s14 offen sc1
    buffer_load_dwordx4 v[196:199], v233, s[44:47], s15 offen sc1
    v_subrev_u32 v234, 9216, v224
    s_cmp_lg_u32 s3, 4
    s_cbranch_scc1 K_unp
    buffer_load_dwordx2 v[112:113], v226, s[44:47], s7 offen sc1
    s_waitcnt vmcnt(1)
    s_branch K_uw
K_unp:
    s_waitcnt vmcnt(0)
K_uw:
    ds_write_b128 v234, v[192:195]
    ds_write_b128 v234, v[196:199] offset:128
    ds_write_b32 v28, v29 offset:112
    s_cmp_lg_u32 s3, 4
    s_cbranch_scc1 K_pwait
    s_mov_b32 s70, 0
    s_branch K_poll1
K_poll:
    buffer_load_dwordx2 v[112:113], v226, s[44:47], s7 offen sc1
K_poll1:
    s_waitcnt vmcnt(0)
    v_xor_b32 v112, s56, v112
    v_xor_b32 v113, s57, v113
    v_or_b32 v112, v112, v113
    v_cmp_ne_u32 vcc, 0, v112
    s_add_u32 s70, s70, 1
    s_cmp_eq_u64 vcc, 0
    s_cbranch_scc1 K_pok
    s_sleep 8
    s_cmp_lt_u32 s70, 0x40000
    s_cbranch_scc1 K_poll
K_pok:
    ds_write_b32 v28, v29 offset:160
    s_branch K_pdone
K_pwait:
    ds_read_b32 v93, v30 offset:176
    s_waitcnt lgkmcnt(0)
    v_readfirstlane_b32 s70, v93
    s_cmp_eq_u32 s70, 1
    s_cbranch_scc1 K_pdone
    s_sleep 1
    s_branch K_pwait
K_pdone:
    buffer_load_dwordx4 v[192:195], v233, s[44:47], s6 offen sc1
    buffer_load_dwordx4 v[196:199], v233, s[44:47], s13 offen sc1
    v_mov_b32 v16, v228
    v_mov_b32 v17, v229
    v_mov_b32 v18, v230
    v_mov_b32 v19, v231
    v_mov_b32 v20, v232
    s_mov_b32 s73, 0
    v_subrev_u32 v24, 16, v1
    v_add_u32 v25, 47, v1
    v_cmp_eq_u32 vcc, 0, v1
    s_nop 1
    v_cndmask_b32 v25, v25, -1, vcc
    v_cmp_gt_u32 vcc, 16, v1
    s_lshl_b32 s74, s73, 6
    s_nop 0
    v_cndmask_b32 v24, v24, v25, vcc
    v_add_u32 v24, s74, v24
    v_add_u32 v26, s74, v1
    v_add_u32 v6, s74, v6
    s_lshl_b32 s70, s67, 2
    s_add_u32 s70, s70, 51952
    v_lshl_add_u32 v2, v26, 4, s70
    s_add_u32 s70, s67, 2
    s_and_b32 s70, s70, 3
    s_lshl_b32 s70, s70, 2
    s_add_u32 s70, s70, 60160
    s_cmp_lt_u32 s67, 2
    s_cselect_b64 vcc, -1, 0
    v_cndmask_b32 v25, v26, v24, vcc
    v_lshl_add_u32 v3, v25, 4, s70
    s_lshr_b32 s70, s67, 1
    s_mul_i32 s70, s70, 2064
    s_add_u32 s70, s70, 84784
    v_lshl_add_u32 v11, v24, 2, s70
    s_and_b32 s70, s67, 1
    s_cmp_eq_u32 s70, 0
    s_cselect_b64 vcc, -1, 0
    s_cselect_b32 s75, 256, 0
    v_mov_b32 v25, 84768
    v_cndmask_b32 v11, v25, v11, vcc
    s_mul_i32 s70, s67, 1152
    v_lshl_add_u32 v21, v6, 1, s70
    s_lshl_b32 s70, s67, 10
    v_lshl_add_u32 v22, v6, 12, s70
    s_lshl_b32 s70, s67, 2
    s_add_u32 s70, s70, 43200
    v_lshl_add_u32 v7, v6, 4, s70
    s_lshl_b32 s70, s73, 5
    s_add_u32 s70, s70, 51392
    v_mov_b32 v23, s70
    s_lshl_b32 s72, s64, 2
    s_lshl_b32 s76, s23, 16
    s_and_b32 s77, s23, s43
    s_lshl_b32 s78, s42, 16
    s_and_b32 s79, s42, s43
    s_sub_u32 s74, 8, s68
W7_p:
    ds_read_b128 v[24:27], v30 offset:0
    s_waitcnt lgkmcnt(0)
    v_and_b32 v24, v24, v25
    v_and_b32 v26, v26, v27
    v_and_b32 v24, v24, v26
    s_nop 0
    v_readfirstlane_b32 s4, v24
    s_cmp_eq_u32 s4, 1
    s_cbranch_scc1 W7_d
    s_sleep 1
    s_branch W7_p
W7_d:
    ds_read_b64_tr_b16 v[64:65], v17 offset:32
    ds_read_b64_tr_b16 v[66:67], v17 offset:0
    ds_read_b64_tr_b16 v[68:69], v17 offset:288
    ds_read_b64_tr_b16 v[70:71], v17 offset:256
    ds_read_b64_tr_b16 v[72:73], v17 offset:544
    ds_read_b64_tr_b16 v[74:75], v17 offset:512
    ds_read_b64_tr_b16 v[76:77], v17 offset:800
    ds_read_b64_tr_b16 v[78:79], v17 offset:768
    ds_read_b64_tr_b16 v[80:81], v17 offset:1056
    ds_read_b64_tr_b16 v[82:83], v17 offset:1024
    ds_read_b64_tr_b16 v[84:85], v17 offset:1312
    ds_read_b64_tr_b16 v[86:87], v17 offset:1280
    ds_read_b64_tr_b16 v[88:89], v17 offset:1568
    ds_read_b64_tr_b16 v[90:91], v17 offset:1536
    ds_read_b64_tr_b16 v[92:93], v17 offset:1824
    ds_read_b64_tr_b16 v[94:95], v17 offset:1792
    ds_read_b64_tr_b16 v[96:97], v17 offset:2080
    ds_read_b64_tr_b16 v[98:99], v17 offset:2048
    ds_read_b64_tr_b16 v[100:101], v17 offset:2336
    ds_read_b64_tr_b16 v[102:103], v17 offset:2304
    ds_read_b64_tr_b16 v[104:105], v17 offset:2592
    ds_read_b64_tr_b16 v[106:107], v17 offset:2560
    ds_read_b64_tr_b16 v[108:109], v17 offset:2848
    ds_read_b64_tr_b16 v[110:111], v17 offset:2816
    ds_read_b64_tr_b16 v[112:113], v17 offset:3104
    ds_read_b64_tr_b16 v[114:115], v17 offset:3072
    ds_read_b64_tr_b16 v[116:117], v17 offset:3360
    ds_read_b64_tr_b16 v[118:119], v17 offset:3328
    ds_read_b64_tr_b16 v[120:121], v17 offset:3616
    ds_read_b64_tr_b16 v[122:123], v17 offset:3584
    ds_read_b64_tr_b16 v[124:125], v17 offset:3872
    ds_read_b64_tr_b16 v[126:127], v17 offset:3840
    s_waitcnt vmcnt(1)
    ds_write_b128 v224, v[192:195]
    s_waitcnt vmcnt(0)
    ds_write_b128 v224, v[196:199] offset:128
    ds_write_b32 v28, v29 offset:128
    s_setprio 2
    s_branch K_convB
K_csetup:
    s_lshl_b32 s70, s3, 1
    s_mul_i32 s70, s70, 1152
    s_add_u32 s70, s70, 8
    v_lshlrev_b32 v16, 3, v4
    v_lshl_add_u32 v16, v5, 4, v16
    v_add_u32 v16, s70, v16
    v_and_b32 v22, 3, v1
    v_bfe_u32 v23, v1, 2, 2
    v_sub_u32 v22, v22, v23
    v_lshlrev_b32 v22, 3, v22
    v_lshlrev_b32 v23, 6, v5
    v_sub_u32 v22, v22, v23
    s_lshl_b32 s70, s68, 2
    s_add_u32 s70, s70, s69
    s_mul_i32 s70, s70, 4128
    s_add_u32 s70, s70, 18656
    v_add_u32 v17, s70, v22
    s_cmp_eq_u32 s68, 0
    s_mov_b32 s71, 51936
    s_cselect_b32 s71, 93024, s71
    s_mul_i32 s70, s67, 8208
    s_add_u32 s70, s70, s71
    s_add_u32 s72, s70, 16
    v_lshl_add_u32 v18, v1, 4, s72
    s_mul_i32 s72, s67, 2064
    s_add_u32 s72, s72, s71
    s_add_u32 s72, s72, 32832
    s_add_u32 s73, s72, 16
    v_lshl_add_u32 v19, v1, 2, s73
    s_lshl_b32 s73, s3, 2
    s_add_u32 s73, s73, 51392
    v_mov_b32 v20, s73
    v_mov_b32 v22, s70
    v_mov_b32 v23, s72
W8_p:
    ds_read_b128 v[24:27], v30 offset:96
    s_waitcnt lgkmcnt(0)
    v_and_b32 v24, v24, v25
    v_and_b32 v26, v26, v27
    v_and_b32 v24, v24, v26
    s_nop 0
    v_readfirstlane_b32 s4, v24
    s_cmp_eq_u32 s4, 1
    s_cbranch_scc1 W8_d
    s_sleep 1
    s_branch W8_p
W8_d:
    s_mov_b32 s73, 7
    v_subrev_u32 v24, 16, v1
    v_add_u32 v25, 47, v1
    v_cmp_eq_u32 vcc, 0, v1
    s_nop 1
    v_cndmask_b32 v25, v25, -1, vcc
    v_cmp_gt_u32 vcc, 16, v1
    s_lshl_b32 s74, s73, 6
    s_nop 0
    v_cndmask_b32 v24, v24, v25, vcc
    v_add_u32 v24, s74, v24
    v_add_u32 v26, s74, v1
    v_add_u32 v6, s74, v6
    s_lshl_b32 s70, s67, 2
    s_add_u32 s70, s70, 51952
    v_lshl_add_u32 v2, v26, 4, s70
    s_add_u32 s70, s67, 2
    s_and_b32 s70, s70, 3
    s_lshl_b32 s70, s70, 2
    s_add_u32 s70, s70, 60160
    s_cmp_lt_u32 s67, 2
    s_cselect_b64 vcc, -1, 0
    v_cndmask_b32 v25, v26, v24, vcc
    v_lshl_add_u32 v3, v25, 4, s70
    s_lshr_b32 s70, s67, 1
    s_mul_i32 s70, s70, 2064
    s_add_u32 s70, s70, 84784
    v_lshl_add_u32 v11, v24, 2, s70
    s_and_b32 s70, s67, 1
    s_cmp_eq_u32 s70, 0
    s_cselect_b64 vcc, -1, 0
    s_cselect_b32 s75, 256, 0
    v_mov_b32 v25, 84768
    v_cndmask_b32 v11, v25, v11, vcc
    s_mul_i32 s70, s67, 1152
    v_lshl_add_u32 v21, v6, 1, s70
    s_lshl_b32 s70, s67, 10
    v_lshl_add_u32 v22, v6, 12, s70
    s_lshl_b32 s70, s67, 2
    s_add_u32 s70, s70, 43200
    v_lshl_add_u32 v7, v6, 4, s70
    s_lshl_b32 s70, s73, 5
    s_add_u32 s70, s70, 51392
    v_mov_b32 v23, s70
    s_lshl_b32 s72, s64, 2
    s_lshl_b32 s76, s23, 16
    s_and_b32 s77, s23, s43
    s_lshl_b32 s78, s42, 16
    s_and_b32 s79, s42, s43
    s_sub_u32 s74, 8, s68
W9_p:
    ds_read_b128 v[24:27], v30 offset:240
    s_waitcnt lgkmcnt(0)
    v_and_b32 v24, v24, v25
    v_and_b32 v26, v26, v27
    v_and_b32 v24, v24, v26
    s_nop 0
    v_readfirstlane_b32 s4, v24
    s_cmp_eq_u32 s4, 1
    s_cbranch_scc1 W9_d
    s_sleep 1
    s_branch W9_p
W9_d:
    ds_read_b64_tr_b16 v[64:65], v17 offset:32
    ds_read_b64_tr_b16 v[66:67], v17 offset:0
    ds_read_b64_tr_b16 v[68:69], v17 offset:8288
    ds_read_b64_tr_b16 v[70:71], v17 offset:8256
    ds_read_b64_tr_b16 v[72:73], v17 offset:288
    ds_read_b64_tr_b16 v[74:75], v17 offset:256
    ds_read_b64_tr_b16 v[76:77], v17 offset:8544
    ds_read_b64_tr_b16 v[78:79], v17 offset:8512
    ds_read_b64_tr_b16 v[80:81], v17 offset:544
    ds_read_b64_tr_b16 v[82:83], v17 offset:512
    ds_read_b64_tr_b16 v[84:85], v17 offset:8800
    ds_read_b64_tr_b16 v[86:87], v17 offset:8768
    ds_read_b64_tr_b16 v[88:89], v17 offset:800
    ds_read_b64_tr_b16 v[90:91], v17 offset:768
    ds_read_b64_tr_b16 v[92:93], v17 offset:9056
    ds_read_b64_tr_b16 v[94:95], v17 offset:9024
    ds_read_b64_tr_b16 v[96:97], v17 offset:1056
    ds_read_b64_tr_b16 v[98:99], v17 offset:1024
    ds_read_b64_tr_b16 v[100:101], v17 offset:9312
    ds_read_b64_tr_b16 v[102:103], v17 offset:9280
    ds_read_b64_tr_b16 v[104:105], v17 offset:1312
    ds_read_b64_tr_b16 v[106:107], v17 offset:1280
    ds_read_b64_tr_b16 v[108:109], v17 offset:9568
    ds_read_b64_tr_b16 v[110:111], v17 offset:9536
    ds_read_b64_tr_b16 v[112:113], v17 offset:1568
    ds_read_b64_tr_b16 v[114:115], v17 offset:1536
    ds_read_b64_tr_b16 v[116:117], v17 offset:9824
    ds_read_b64_tr_b16 v[118:119], v17 offset:9792
    ds_read_b64_tr_b16 v[120:121], v17 offset:1824
    ds_read_b64_tr_b16 v[122:123], v17 offset:1792
    ds_read_b64_tr_b16 v[124:125], v17 offset:10080
    ds_read_b64_tr_b16 v[126:127], v17 offset:10048
    ds_read_b64_tr_b16 v[128:129], v17 offset:2080
    ds_read_b64_tr_b16 v[130:131], v17 offset:2048
    ds_read_b64_tr_b16 v[132:133], v17 offset:10336
    ds_read_b64_tr_b16 v[134:135], v17 offset:10304
    ds_read_b64_tr_b16 v[136:137], v17 offset:2336
    ds_read_b64_tr_b16 v[138:139], v17 offset:2304
    ds_read_b64_tr_b16 v[140:141], v17 offset:10592
    ds_read_b64_tr_b16 v[142:143], v17 offset:10560
    ds_read_b64_tr_b16 v[144:145], v17 offset:2592
    ds_read_b64_tr_b16 v[146:147], v17 offset:2560
    ds_read_b64_tr_b16 v[148:149], v17 offset:10848
    ds_read_b64_tr_b16 v[150:151], v17 offset:10816
    ds_read_b64_tr_b16 v[152:153], v17 offset:2848
    ds_read_b64_tr_b16 v[154:155], v17 offset:2816
    ds_read_b64_tr_b16 v[156:157], v17 offset:11104
    ds_read_b64_tr_b16 v[158:159], v17 offset:11072
    ds_read_b64_tr_b16 v[160:161], v17 offset:3104
    ds_read_b64_tr_b16 v[162:163], v17 offset:3072
    ds_read_b64_tr_b16 v[164:165], v17 offset:11360
    ds_read_b64_tr_b16 v[166:167], v17 offset:11328
    ds_read_b64_tr_b16 v[168:169], v17 offset:3360
    ds_read_b64_tr_b16 v[170:171], v17 offset:3328
    ds_read_b64_tr_b16 v[172:173], v17 offset:11616
    ds_read_b64_tr_b16 v[174:175], v17 offset:11584
    ds_read_b64_tr_b16 v[176:177], v17 offset:3616
    ds_read_b64_tr_b16 v[178:179], v17 offset:3584
    ds_read_b64_tr_b16 v[180:181], v17 offset:11872
    ds_read_b64_tr_b16 v[182:183], v17 offset:11840
    ds_read_b64_tr_b16 v[184:185], v17 offset:3872
    ds_read_b64_tr_b16 v[186:187], v17 offset:3840
    ds_read_b64_tr_b16 v[188:189], v17 offset:12128
    ds_read_b64_tr_b16 v[190:191], v17 offset:12096
W10_p:
    ds_read_b128 v[24:27], v30 offset:128
    s_waitcnt lgkmcnt(0)
    v_and_b32 v24, v24, v25
    v_and_b32 v26, v26, v27
    v_and_b32 v24, v24, v26
    s_nop 0
    v_readfirstlane_b32 s4, v24
    s_cmp_eq_u32 s4, 1
    s_cbranch_scc1 W10_d
    s_sleep 1
    s_branch W10_p
W10_d:
    v_mov_b32 v24, 0
    v_mov_b32 v25, 0
    v_mov_b32 v26, 0
    v_mov_b32 v27, 0
    v_subrev_u32 v31, 16, v18
    v_subrev_u32 v8, 16, v19
    s_mov_b64 exec, 1
    ds_write_b128 v31, v[24:27]
    ds_write_b128 v8, v[24:27]
    s_mov_b64 exec, -1
    s_setprio 0
    ds_read_b64 v[32:33], v16 offset:0
    ds_read_b64 v[34:35], v16 offset:8
    ds_read_b64 v[36:37], v16 offset:1152
    ds_read_b64 v[38:39], v16 offset:1160
    ds_read_b64 v[40:41], v16 offset:64
    ds_read_b64 v[42:43], v16 offset:72
    ds_read_b64 v[44:45], v16 offset:1216
    ds_read_b64 v[46:47], v16 offset:1224
    ds_read_b64 v[48:49], v16 offset:128
    ds_read_b64 v[50:51], v16 offset:136
    ds_read_b64 v[52:53], v16 offset:1280
    ds_read_b64 v[54:55], v16 offset:1288
    s_waitcnt lgkmcnt(10)
    v_mfma_f32_16x16x32_bf16 v[192:195], v[72:75], v[32:35], 0
    v_mfma_f32_16x16x32_bf16 v[192:195], v[76:79], v[32:35], v[192:195]
    s_waitcnt lgkmcnt(8)
    v_mfma_f32_16x16x32_bf16 v[224:227], v[72:75], v[36:39], 0
    v_mfma_f32_16x16x32_bf16 v[224:227], v[76:79], v[36:39], v[224:227]
    ds_read_b64 v[56:57], v16 offset:192
    ds_read_b64 v[58:59], v16 offset:200
    ds_read_b64 v[60:61], v16 offset:1344
    ds_read_b64 v[62:63], v16 offset:1352
    v_mfma_f32_16x16x32_bf16 v[196:199], v[88:91], v[32:35], 0
    v_mfma_f32_16x16x32_bf16 v[196:199], v[92:95], v[32:35], v[196:199]
    v_mfma_f32_16x16x32_bf16 v[228:231], v[88:91], v[36:39], 0
    v_mfma_f32_16x16x32_bf16 v[228:231], v[92:95], v[36:39], v[228:231]
    v_mfma_f32_16x16x32_bf16 v[200:203], v[104:107], v[32:35], 0
    v_mfma_f32_16x16x32_bf16 v[200:203], v[108:111], v[32:35], v[200:203]
    v_mfma_f32_16x16x32_bf16 v[232:235], v[104:107], v[36:39], 0
    v_mfma_f32_16x16x32_bf16 v[232:235], v[108:111], v[36:39], v[232:235]
    v_mfma_f32_16x16x32_bf16 v[204:207], v[120:123], v[32:35], 0
    v_mfma_f32_16x16x32_bf16 v[204:207], v[124:127], v[32:35], v[204:207]
    v_mfma_f32_16x16x32_bf16 v[236:239], v[120:123], v[36:39], 0
    v_mfma_f32_16x16x32_bf16 v[236:239], v[124:127], v[36:39], v[236:239]
    v_mfma_f32_16x16x32_bf16 v[208:211], v[136:139], v[32:35], 0
    v_mfma_f32_16x16x32_bf16 v[208:211], v[140:143], v[32:35], v[208:211]
    v_mfma_f32_16x16x32_bf16 v[240:243], v[136:139], v[36:39], 0
    v_mfma_f32_16x16x32_bf16 v[240:243], v[140:143], v[36:39], v[240:243]
    v_mfma_f32_16x16x32_bf16 v[212:215], v[152:155], v[32:35], 0
    v_mfma_f32_16x16x32_bf16 v[212:215], v[156:159], v[32:35], v[212:215]
    v_mfma_f32_16x16x32_bf16 v[244:247], v[152:155], v[36:39], 0
    v_mfma_f32_16x16x32_bf16 v[244:247], v[156:159], v[36:39], v[244:247]
    v_mfma_f32_16x16x32_bf16 v[216:219], v[168:171], v[32:35], 0
    v_mfma_f32_16x16x32_bf16 v[216:219], v[172:175], v[32:35], v[216:219]
    v_mfma_f32_16x16x32_bf16 v[248:251], v[168:171], v[36:39], 0
    v_mfma_f32_16x16x32_bf16 v[248:251], v[172:175], v[36:39], v[248:251]
    v_mfma_f32_16x16x32_bf16 v[220:223], v[184:187], v[32:35], 0
    v_mfma_f32_16x16x32_bf16 v[220:223], v[188:191], v[32:35], v[220:223]
    v_mfma_f32_16x16x32_bf16 v[252:255], v[184:187], v[36:39], 0
    v_mfma_f32_16x16x32_bf16 v[252:255], v[188:191], v[36:39], v[252:255]
    s_waitcnt lgkmcnt(10)
    v_mfma_f32_16x16x32_bf16 v[192:195], v[64:67], v[40:43], v[192:195]
    v_mfma_f32_16x16x32_bf16 v[192:195], v[68:71], v[40:43], v[192:195]
    s_waitcnt lgkmcnt(8)
    v_mfma_f32_16x16x32_bf16 v[224:227], v[64:67], v[44:47], v[224:227]
    v_mfma_f32_16x16x32_bf16 v[224:227], v[68:71], v[44:47], v[224:227]
    ds_read_b64 v[32:33], v16 offset:256
    ds_read_b64 v[34:35], v16 offset:264
    ds_read_b64 v[36:37], v16 offset:1408
    ds_read_b64 v[38:39], v16 offset:1416
    v_mfma_f32_16x16x32_bf16 v[196:199], v[80:83], v[40:43], v[196:199]
    v_mfma_f32_16x16x32_bf16 v[196:199], v[84:87], v[40:43], v[196:199]
    v_mfma_f32_16x16x32_bf16 v[228:231], v[80:83], v[44:47], v[228:231]
    v_mfma_f32_16x16x32_bf16 v[228:231], v[84:87], v[44:47], v[228:231]
    v_mfma_f32_16x16x32_bf16 v[200:203], v[96:99], v[40:43], v[200:203]
    v_mfma_f32_16x16x32_bf16 v[200:203], v[100:103], v[40:43], v[200:203]
    v_mfma_f32_16x16x32_bf16 v[232:235], v[96:99], v[44:47], v[232:235]
    v_mfma_f32_16x16x32_bf16 v[232:235], v[100:103], v[44:47], v[232:235]
    v_mfma_f32_16x16x32_bf16 v[204:207], v[112:115], v[40:43], v[204:207]
    v_mfma_f32_16x16x32_bf16 v[204:207], v[116:119], v[40:43], v[204:207]
    v_mfma_f32_16x16x32_bf16 v[236:239], v[112:115], v[44:47], v[236:239]
    v_mfma_f32_16x16x32_bf16 v[236:239], v[116:119], v[44:47], v[236:239]
    v_mfma_f32_16x16x32_bf16 v[208:211], v[128:131], v[40:43], v[208:211]
    v_mfma_f32_16x16x32_bf16 v[208:211], v[132:135], v[40:43], v[208:211]
    v_mfma_f32_16x16x32_bf16 v[240:243], v[128:131], v[44:47], v[240:243]
    v_mfma_f32_16x16x32_bf16 v[240:243], v[132:135], v[44:47], v[240:243]
    v_mfma_f32_16x16x32_bf16 v[212:215], v[144:147], v[40:43], v[212:215]
    v_mfma_f32_16x16x32_bf16 v[212:215], v[148:151], v[40:43], v[212:215]
    v_mfma_f32_16x16x32_bf16 v[244:247], v[144:147], v[44:47], v[244:247]
    v_mfma_f32_16x16x32_bf16 v[244:247], v[148:151], v[44:47], v[244:247]
    v_mfma_f32_16x16x32_bf16 v[216:219], v[160:163], v[40:43], v[216:219]
    v_mfma_f32_16x16x32_bf16 v[216:219], v[164:167], v[40:43], v[216:219]
    v_mfma_f32_16x16x32_bf16 v[248:251], v[160:163], v[44:47], v[248:251]
    v_mfma_f32_16x16x32_bf16 v[248:251], v[164:167], v[44:47], v[248:251]
    v_mfma_f32_16x16x32_bf16 v[220:223], v[176:179], v[40:43], v[220:223]
    v_mfma_f32_16x16x32_bf16 v[220:223], v[180:183], v[40:43], v[220:223]
    v_mfma_f32_16x16x32_bf16 v[252:255], v[176:179], v[44:47], v[252:255]
    v_mfma_f32_16x16x32_bf16 v[252:255], v[180:183], v[44:47], v[252:255]
    s_waitcnt lgkmcnt(10)
    v_mfma_f32_16x16x32_bf16 v[196:199], v[72:75], v[48:51], v[196:199]
    v_mfma_f32_16x16x32_bf16 v[196:199], v[76:79], v[48:51], v[196:199]
    s_waitcnt lgkmcnt(8)
    v_mfma_f32_16x16x32_bf16 v[228:231], v[72:75], v[52:55], v[228:231]
    v_mfma_f32_16x16x32_bf16 v[228:231], v[76:79], v[52:55], v[228:231]
    ds_read_b64 v[40:41], v16 offset:320
    ds_read_b64 v[42:43], v16 offset:328
    ds_read_b64 v[44:45], v16 offset:1472
    ds_read_b64 v[46:47], v16 offset:1480
    v_mfma_f32_16x16x32_bf16 v[200:203], v[88:91], v[48:51], v[200:203]
    v_mfma_f32_16x16x32_bf16 v[200:203], v[92:95], v[48:51], v[200:203]
    v_mfma_f32_16x16x32_bf16 v[232:235], v[88:91], v[52:55], v[232:235]
    v_mfma_f32_16x16x32_bf16 v[232:235], v[92:95], v[52:55], v[232:235]
    v_add_f32 v193, v193, v224
    v_add_f32 v194, v194, v225
    v_add_f32 v195, v195, v226
    ds_write_b32 v19, v227 offset:0
    ds_write_b128 v18, v[192:195] offset:0
    ds_write_b32 v20, v29 offset:0
    v_mfma_f32_16x16x32_bf16 v[204:207], v[104:107], v[48:51], v[204:207]
    v_mfma_f32_16x16x32_bf16 v[204:207], v[108:111], v[48:51], v[204:207]
    v_mfma_f32_16x16x32_bf16 v[236:239], v[104:107], v[52:55], v[236:239]
    v_mfma_f32_16x16x32_bf16 v[236:239], v[108:111], v[52:55], v[236:239]
    v_mfma_f32_16x16x32_bf16 v[208:211], v[120:123], v[48:51], v[208:211]
    v_mfma_f32_16x16x32_bf16 v[208:211], v[124:127], v[48:51], v[208:211]
    v_mfma_f32_16x16x32_bf16 v[240:243], v[120:123], v[52:55], v[240:243]
    v_mfma_f32_16x16x32_bf16 v[240:243], v[124:127], v[52:55], v[240:243]
    v_mfma_f32_16x16x32_bf16 v[212:215], v[136:139], v[48:51], v[212:215]
    v_mfma_f32_16x16x32_bf16 v[212:215], v[140:143], v[48:51], v[212:215]
    v_mfma_f32_16x16x32_bf16 v[244:247], v[136:139], v[52:55], v[244:247]
    v_mfma_f32_16x16x32_bf16 v[244:247], v[140:143], v[52:55], v[244:247]
    v_mfma_f32_16x16x32_bf16 v[216:219], v[152:155], v[48:51], v[216:219]
    v_mfma_f32_16x16x32_bf16 v[216:219], v[156:159], v[48:51], v[216:219]
    v_mfma_f32_16x16x32_bf16 v[248:251], v[152:155], v[52:55], v[248:251]
    v_mfma_f32_16x16x32_bf16 v[248:251], v[156:159], v[52:55], v[248:251]
    v_mfma_f32_16x16x32_bf16 v[220:223], v[168:171], v[48:51], v[220:223]
    v_mfma_f32_16x16x32_bf16 v[220:223], v[172:175], v[48:51], v[220:223]
    v_mfma_f32_16x16x32_bf16 v[252:255], v[168:171], v[52:55], v[252:255]
    v_mfma_f32_16x16x32_bf16 v[252:255], v[172:175], v[52:55], v[252:255]
    s_waitcnt lgkmcnt(13)
    v_mfma_f32_16x16x32_bf16 v[196:199], v[64:67], v[56:59], v[196:199]
    v_mfma_f32_16x16x32_bf16 v[196:199], v[68:71], v[56:59], v[196:199]
    s_waitcnt lgkmcnt(11)
    v_mfma_f32_16x16x32_bf16 v[228:231], v[64:67], v[60:63], v[228:231]
    v_mfma_f32_16x16x32_bf16 v[228:231], v[68:71], v[60:63], v[228:231]
    ds_read_b64 v[48:49], v16 offset:384
    ds_read_b64 v[50:51], v16 offset:392
    ds_read_b64 v[52:53], v16 offset:1536
    ds_read_b64 v[54:55], v16 offset:1544
    v_mfma_f32_16x16x32_bf16 v[200:203], v[80:83], v[56:59], v[200:203]
    v_mfma_f32_16x16x32_bf16 v[200:203], v[84:87], v[56:59], v[200:203]
    v_mfma_f32_16x16x32_bf16 v[232:235], v[80:83], v[60:63], v[232:235]
    v_mfma_f32_16x16x32_bf16 v[232:235], v[84:87], v[60:63], v[232:235]
    v_mfma_f32_16x16x32_bf16 v[204:207], v[96:99], v[56:59], v[204:207]
    v_mfma_f32_16x16x32_bf16 v[204:207], v[100:103], v[56:59], v[204:207]
    v_mfma_f32_16x16x32_bf16 v[236:239], v[96:99], v[60:63], v[236:239]
    v_mfma_f32_16x16x32_bf16 v[236:239], v[100:103], v[60:63], v[236:239]
    v_mfma_f32_16x16x32_bf16 v[208:211], v[112:115], v[56:59], v[208:211]
    v_mfma_f32_16x16x32_bf16 v[208:211], v[116:119], v[56:59], v[208:211]
    v_mfma_f32_16x16x32_bf16 v[240:243], v[112:115], v[60:63], v[240:243]
    v_mfma_f32_16x16x32_bf16 v[240:243], v[116:119], v[60:63], v[240:243]
    v_mfma_f32_16x16x32_bf16 v[212:215], v[128:131], v[56:59], v[212:215]
    v_mfma_f32_16x16x32_bf16 v[212:215], v[132:135], v[56:59], v[212:215]
    v_mfma_f32_16x16x32_bf16 v[244:247], v[128:131], v[60:63], v[244:247]
    v_mfma_f32_16x16x32_bf16 v[244:247], v[132:135], v[60:63], v[244:247]
    v_mfma_f32_16x16x32_bf16 v[216:219], v[144:147], v[56:59], v[216:219]
    v_mfma_f32_16x16x32_bf16 v[216:219], v[148:151], v[56:59], v[216:219]
    v_mfma_f32_16x16x32_bf16 v[248:251], v[144:147], v[60:63], v[248:251]
    v_mfma_f32_16x16x32_bf16 v[248:251], v[148:151], v[60:63], v[248:251]
    v_mfma_f32_16x16x32_bf16 v[220:223], v[160:163], v[56:59], v[220:223]
    v_mfma_f32_16x16x32_bf16 v[220:223], v[164:167], v[56:59], v[220:223]
    v_mfma_f32_16x16x32_bf16 v[252:255], v[160:163], v[60:63], v[252:255]
    v_mfma_f32_16x16x32_bf16 v[252:255], v[164:167], v[60:63], v[252:255]
    s_waitcnt lgkmcnt(13)
    v_mfma_f32_16x16x32_bf16 v[200:203], v[72:75], v[32:35], v[200:203]
    v_mfma_f32_16x16x32_bf16 v[200:203], v[76:79], v[32:35], v[200:203]
    s_waitcnt lgkmcnt(11)
    v_mfma_f32_16x16x32_bf16 v[232:235], v[72:75], v[36:39], v[232:235]
    v_mfma_f32_16x16x32_bf16 v[232:235], v[76:79], v[36:39], v[232:235]
    ds_read_b64 v[56:57], v16 offset:448
    ds_read_b64 v[58:59], v16 offset:456
    ds_read_b64 v[60:61], v16 offset:1600
    ds_read_b64 v[62:63], v16 offset:1608
    v_mfma_f32_16x16x32_bf16 v[204:207], v[88:91], v[32:35], v[204:207]
    v_mfma_f32_16x16x32_bf16 v[204:207], v[92:95], v[32:35], v[204:207]
    v_mfma_f32_16x16x32_bf16 v[236:239], v[88:91], v[36:39], v[236:239]
    v_mfma_f32_16x16x32_bf16 v[236:239], v[92:95], v[36:39], v[236:239]
    v_add_f32 v197, v197, v228
    v_add_f32 v198, v198, v229
    v_add_f32 v199, v199, v230
    ds_write_b32 v19, v231 offset:256
    ds_write_b128 v18, v[196:199] offset:1024
    ds_write_b32 v20, v29 offset:32
    v_mfma_f32_16x16x32_bf16 v[208:211], v[104:107], v[32:35], v[208:211]
    v_mfma_f32_16x16x32_bf16 v[208:211], v[108:111], v[32:35], v[208:211]
    v_mfma_f32_16x16x32_bf16 v[240:243], v[104:107], v[36:39], v[240:243]
    v_mfma_f32_16x16x32_bf16 v[240:243], v[108:111], v[36:39], v[240:243]
    v_mfma_f32_16x16x32_bf16 v[212:215], v[120:123], v[32:35], v[212:215]
    v_mfma_f32_16x16x32_bf16 v[212:215], v[124:127], v[32:35], v[212:215]
    v_mfma_f32_16x16x32_bf16 v[244:247], v[120:123], v[36:39], v[244:247]
    v_mfma_f32_16x16x32_bf16 v[244:247], v[124:127], v[36:39], v[244:247]
    v_mfma_f32_16x16x32_bf16 v[216:219], v[136:139], v[32:35], v[216:219]
    v_mfma_f32_16x16x32_bf16 v[216:219], v[140:143], v[32:35], v[216:219]
    v_mfma_f32_16x16x32_bf16 v[248:251], v[136:139], v[36:39], v[248:251]
    v_mfma_f32_16x16x32_bf16 v[248:251], v[140:143], v[36:39], v[248:251]
    v_mfma_f32_16x16x32_bf16 v[220:223], v[152:155], v[32:35], v[220:223]
    v_mfma_f32_16x16x32_bf16 v[220:223], v[156:159], v[32:35], v[220:223]
    v_mfma_f32_16x16x32_bf16 v[252:255], v[152:155], v[36:39], v[252:255]
    v_mfma_f32_16x16x32_bf16 v[252:255], v[156:159], v[36:39], v[252:255]
    s_waitcnt lgkmcnt(15)
    v_mfma_f32_16x16x32_bf16 v[200:203], v[64:67], v[40:43], v[200:203]
    v_mfma_f32_16x16x32_bf16 v[200:203], v[68:71], v[40:43], v[200:203]
    s_waitcnt lgkmcnt(14)
    v_mfma_f32_16x16x32_bf16 v[232:235], v[64:67], v[44:47], v[232:235]
    v_mfma_f32_16x16x32_bf16 v[232:235], v[68:71], v[44:47], v[232:235]
    ds_read_b64 v[32:33], v16 offset:512
    ds_read_b64 v[34:35], v16 offset:520
    ds_read_b64 v[36:37], v16 offset:1664
    ds_read_b64 v[38:39], v16 offset:1672
    v_mfma_f32_16x16x32_bf16 v[204:207], v[80:83], v[40:43], v[204:207]
    v_mfma_f32_16x16x32_bf16 v[204:207], v[84:87], v[40:43], v[204:207]
    v_mfma_f32_16x16x32_bf16 v[236:239], v[80:83], v[44:47], v[236:239]
    v_mfma_f32_16x16x32_bf16 v[236:239], v[84:87], v[44:47], v[236:239]
    v_mfma_f32_16x16x32_bf16 v[208:211], v[96:99], v[40:43], v[208:211]
    v_mfma_f32_16x16x32_bf16 v[208:211], v[100:103], v[40:43], v[208:211]
    v_mfma_f32_16x16x32_bf16 v[240:243], v[96:99], v[44:47], v[240:243]
    v_mfma_f32_16x16x32_bf16 v[240:243], v[100:103], v[44:47], v[240:243]
    v_mfma_f32_16x16x32_bf16 v[212:215], v[112:115], v[40:43], v[212:215]
    v_mfma_f32_16x16x32_bf16 v[212:215], v[116:119], v[40:43], v[212:215]
    v_mfma_f32_16x16x32_bf16 v[244:247], v[112:115], v[44:47], v[244:247]
    v_mfma_f32_16x16x32_bf16 v[244:247], v[116:119], v[44:47], v[244:247]
    v_mfma_f32_16x16x32_bf16 v[216:219], v[128:131], v[40:43], v[216:219]
    v_mfma_f32_16x16x32_bf16 v[216:219], v[132:135], v[40:43], v[216:219]
    v_mfma_f32_16x16x32_bf16 v[248:251], v[128:131], v[44:47], v[248:251]
    v_mfma_f32_16x16x32_bf16 v[248:251], v[132:135], v[44:47], v[248:251]
    v_mfma_f32_16x16x32_bf16 v[220:223], v[144:147], v[40:43], v[220:223]
    v_mfma_f32_16x16x32_bf16 v[220:223], v[148:151], v[40:43], v[220:223]
    v_mfma_f32_16x16x32_bf16 v[252:255], v[144:147], v[44:47], v[252:255]
    v_mfma_f32_16x16x32_bf16 v[252:255], v[148:151], v[44:47], v[252:255]
    s_waitcnt lgkmcnt(13)
    v_mfma_f32_16x16x32_bf16 v[204:207], v[72:75], v[48:51], v[204:207]
    v_mfma_f32_16x16x32_bf16 v[204:207], v[76:79], v[48:51], v[204:207]
    s_waitcnt lgkmcnt(11)
    v_mfma_f32_16x16x32_bf16 v[236:239], v[72:75], v[52:55], v[236:239]
    v_mfma_f32_16x16x32_bf16 v[236:239], v[76:79], v[52:55], v[236:239]
    ds_read_b64 v[40:41], v16 offset:576
    ds_read_b64 v[42:43], v16 offset:584
    ds_read_b64 v[44:45], v16 offset:1728
    ds_read_b64 v[46:47], v16 offset:1736
    v_mfma_f32_16x16x32_bf16 v[208:211], v[88:91], v[48:51], v[208:211]
    v_mfma_f32_16x16x32_bf16 v[208:211], v[92:95], v[48:51], v[208:211]
    v_mfma_f32_16x16x32_bf16 v[240:243], v[88:91], v[52:55], v[240:243]
    v_mfma_f32_16x16x32_bf16 v[240:243], v[92:95], v[52:55], v[240:243]
    v_add_f32 v201, v201, v232
    v_add_f32 v202, v202, v233
    v_add_f32 v203, v203, v234
    ds_write_b32 v19, v235 offset:512
    ds_write_b128 v18, v[200:203] offset:2048
    ds_write_b32 v20, v29 offset:64
    v_mfma_f32_16x16x32_bf16 v[212:215], v[104:107], v[48:51], v[212:215]
    v_mfma_f32_16x16x32_bf16 v[212:215], v[108:111], v[48:51], v[212:215]
    v_mfma_f32_16x16x32_bf16 v[244:247], v[104:107], v[52:55], v[244:247]
    v_mfma_f32_16x16x32_bf16 v[244:247], v[108:111], v[52:55], v[244:247]
    v_mfma_f32_16x16x32_bf16 v[216:219], v[120:123], v[48:51], v[216:219]
    v_mfma_f32_16x16x32_bf16 v[216:219], v[124:127], v[48:51], v[216:219]
    v_mfma_f32_16x16x32_bf16 v[248:251], v[120:123], v[52:55], v[248:251]
    v_mfma_f32_16x16x32_bf16 v[248:251], v[124:127], v[52:55], v[248:251]
    v_mfma_f32_16x16x32_bf16 v[220:223], v[136:139], v[48:51], v[220:223]
    v_mfma_f32_16x16x32_bf16 v[220:223], v[140:143], v[48:51], v[220:223]
    v_mfma_f32_16x16x32_bf16 v[252:255], v[136:139], v[52:55], v[252:255]
    v_mfma_f32_16x16x32_bf16 v[252:255], v[140:143], v[52:55], v[252:255]
    s_waitcnt lgkmcnt(15)
    v_mfma_f32_16x16x32_bf16 v[204:207], v[64:67], v[56:59], v[204:207]
    v_mfma_f32_16x16x32_bf16 v[204:207], v[68:71], v[56:59], v[204:207]
    s_waitcnt lgkmcnt(14)
    v_mfma_f32_16x16x32_bf16 v[236:239], v[64:67], v[60:63], v[236:239]
    v_mfma_f32_16x16x32_bf16 v[236:239], v[68:71], v[60:63], v[236:239]
    ds_read_b64 v[48:49], v16 offset:640
    ds_read_b64 v[50:51], v16 offset:648
    ds_read_b64 v[52:53], v16 offset:1792
    ds_read_b64 v[54:55], v16 offset:1800
    v_mfma_f32_16x16x32_bf16 v[208:211], v[80:83], v[56:59], v[208:211]
    v_mfma_f32_16x16x32_bf16 v[208:211], v[84:87], v[56:59], v[208:211]
    v_mfma_f32_16x16x32_bf16 v[240:243], v[80:83], v[60:63], v[240:243]
    v_mfma_f32_16x16x32_bf16 v[240:243], v[84:87], v[60:63], v[240:243]
    v_mfma_f32_16x16x32_bf16 v[212:215], v[96:99], v[56:59], v[212:215]
    v_mfma_f32_16x16x32_bf16 v[212:215], v[100:103], v[56:59], v[212:215]
    v_mfma_f32_16x16x32_bf16 v[244:247], v[96:99], v[60:63], v[244:247]
    v_mfma_f32_16x16x32_bf16 v[244:247], v[100:103], v[60:63], v[244:247]
    v_mfma_f32_16x16x32_bf16 v[216:219], v[112:115], v[56:59], v[216:219]
    v_mfma_f32_16x16x32_bf16 v[216:219], v[116:119], v[56:59], v[216:219]
    v_mfma_f32_16x16x32_bf16 v[248:251], v[112:115], v[60:63], v[248:251]
    v_mfma_f32_16x16x32_bf16 v[248:251], v[116:119], v[60:63], v[248:251]
    v_mfma_f32_16x16x32_bf16 v[220:223], v[128:131], v[56:59], v[220:223]
    v_mfma_f32_16x16x32_bf16 v[220:223], v[132:135], v[56:59], v[220:223]
    v_mfma_f32_16x16x32_bf16 v[252:255], v[128:131], v[60:63], v[252:255]
    v_mfma_f32_16x16x32_bf16 v[252:255], v[132:135], v[60:63], v[252:255]
    s_waitcnt lgkmcnt(13)
    v_mfma_f32_16x16x32_bf16 v[208:211], v[72:75], v[32:35], v[208:211]
    v_mfma_f32_16x16x32_bf16 v[208:211], v[76:79], v[32:35], v[208:211]
    s_waitcnt lgkmcnt(11)
    v_mfma_f32_16x16x32_bf16 v[240:243], v[72:75], v[36:39], v[240:243]
    v_mfma_f32_16x16x32_bf16 v[240:243], v[76:79], v[36:39], v[240:243]
    ds_read_b64 v[56:57], v16 offset:704
    ds_read_b64 v[58:59], v16 offset:712
    ds_read_b64 v[60:61], v16 offset:1856
    ds_read_b64 v[62:63], v16 offset:1864
    v_mfma_f32_16x16x32_bf16 v[212:215], v[88:91], v[32:35], v[212:215]
    v_mfma_f32_16x16x32_bf16 v[212:215], v[92:95], v[32:35], v[212:215]
    v_mfma_f32_16x16x32_bf16 v[244:247], v[88:91], v[36:39], v[244:247]
    v_mfma_f32_16x16x32_bf16 v[244:247], v[92:95], v[36:39], v[244:247]
    v_add_f32 v205, v205, v236
    v_add_f32 v206, v206, v237
    v_add_f32 v207, v207, v238
    ds_write_b32 v19, v239 offset:768
    ds_write_b128 v18, v[204:207] offset:3072
    ds_write_b32 v20, v29 offset:96
    v_mfma_f32_16x16x32_bf16 v[216:219], v[104:107], v[32:35], v[216:219]
    v_mfma_f32_16x16x32_bf16 v[216:219], v[108:111], v[32:35], v[216:219]
    v_mfma_f32_16x16x32_bf16 v[248:251], v[104:107], v[36:39], v[248:251]
    v_mfma_f32_16x16x32_bf16 v[248:251], v[108:111], v[36:39], v[248:251]
    v_mfma_f32_16x16x32_bf16 v[220:223], v[120:123], v[32:35], v[220:223]
    v_mfma_f32_16x16x32_bf16 v[220:223], v[124:127], v[32:35], v[220:223]
    v_mfma_f32_16x16x32_bf16 v[252:255], v[120:123], v[36:39], v[252:255]
    v_mfma_f32_16x16x32_bf16 v[252:255], v[124:127], v[36:39], v[252:255]
    s_waitcnt lgkmcnt(15)
    v_mfma_f32_16x16x32_bf16 v[208:211], v[64:67], v[40:43], v[208:211]
    v_mfma_f32_16x16x32_bf16 v[208:211], v[68:71], v[40:43], v[208:211]
    s_waitcnt lgkmcnt(14)
    v_mfma_f32_16x16x32_bf16 v[240:243], v[64:67], v[44:47], v[240:243]
    v_mfma_f32_16x16x32_bf16 v[240:243], v[68:71], v[44:47], v[240:243]
    ds_read_b64 v[32:33], v16 offset:768
    ds_read_b64 v[34:35], v16 offset:776
    ds_read_b64 v[36:37], v16 offset:1920
    ds_read_b64 v[38:39], v16 offset:1928
    v_mfma_f32_16x16x32_bf16 v[212:215], v[80:83], v[40:43], v[212:215]
    v_mfma_f32_16x16x32_bf16 v[212:215], v[84:87], v[40:43], v[212:215]
    v_mfma_f32_16x16x32_bf16 v[244:247], v[80:83], v[44:47], v[244:247]
    v_mfma_f32_16x16x32_bf16 v[244:247], v[84:87], v[44:47], v[244:247]
    v_mfma_f32_16x16x32_bf16 v[216:219], v[96:99], v[40:43], v[216:219]
    v_mfma_f32_16x16x32_bf16 v[216:219], v[100:103], v[40:43], v[216:219]
    v_mfma_f32_16x16x32_bf16 v[248:251], v[96:99], v[44:47], v[248:251]
    v_mfma_f32_16x16x32_bf16 v[248:251], v[100:103], v[44:47], v[248:251]
    v_mfma_f32_16x16x32_bf16 v[220:223], v[112:115], v[40:43], v[220:223]
    v_mfma_f32_16x16x32_bf16 v[220:223], v[116:119], v[40:43], v[220:223]
    v_mfma_f32_16x16x32_bf16 v[252:255], v[112:115], v[44:47], v[252:255]
    v_mfma_f32_16x16x32_bf16 v[252:255], v[116:119], v[44:47], v[252:255]
    s_waitcnt lgkmcnt(13)
    v_mfma_f32_16x16x32_bf16 v[212:215], v[72:75], v[48:51], v[212:215]
    v_mfma_f32_16x16x32_bf16 v[212:215], v[76:79], v[48:51], v[212:215]
    s_waitcnt lgkmcnt(11)
    v_mfma_f32_16x16x32_bf16 v[244:247], v[72:75], v[52:55], v[244:247]
    v_mfma_f32_16x16x32_bf16 v[244:247], v[76:79], v[52:55], v[244:247]
    ds_read_b64 v[40:41], v16 offset:832
    ds_read_b64 v[42:43], v16 offset:840
    ds_read_b64 v[44:45], v16 offset:1984
    ds_read_b64 v[46:47], v16 offset:1992
    v_mfma_f32_16x16x32_bf16 v[216:219], v[88:91], v[48:51], v[216:219]
    v_mfma_f32_16x16x32_bf16 v[216:219], v[92:95], v[48:51], v[216:219]
    v_mfma_f32_16x16x32_bf16 v[248:251], v[88:91], v[52:55], v[248:251]
    v_mfma_f32_16x16x32_bf16 v[248:251], v[92:95], v[52:55], v[248:251]
    v_add_f32 v209, v209, v240
    v_add_f32 v210, v210, v241
    v_add_f32 v211, v211, v242
    ds_write_b32 v19, v243 offset:1024
    ds_write_b128 v18, v[208:211] offset:4096
    ds_write_b32 v20, v29 offset:128
    v_mfma_f32_16x16x32_bf16 v[220:223], v[104:107], v[48:51], v[220:223]
    v_mfma_f32_16x16x32_bf16 v[220:223], v[108:111], v[48:51], v[220:223]
    v_mfma_f32_16x16x32_bf16 v[252:255], v[104:107], v[52:55], v[252:255]
    v_mfma_f32_16x16x32_bf16 v[252:255], v[108:111], v[52:55], v[252:255]
    s_waitcnt lgkmcnt(15)
    v_mfma_f32_16x16x32_bf16 v[212:215], v[64:67], v[56:59], v[212:215]
    v_mfma_f32_16x16x32_bf16 v[212:215], v[68:71], v[56:59], v[212:215]
    s_waitcnt lgkmcnt(14)
    v_mfma_f32_16x16x32_bf16 v[244:247], v[64:67], v[60:63], v[244:247]
    v_mfma_f32_16x16x32_bf16 v[244:247], v[68:71], v[60:63], v[244:247]
    ds_read_b64 v[48:49], v16 offset:896
    ds_read_b64 v[50:51], v16 offset:904
    ds_read_b64 v[52:53], v16 offset:2048
    ds_read_b64 v[54:55], v16 offset:2056
    v_mfma_f32_16x16x32_bf16 v[216:219], v[80:83], v[56:59], v[216:219]
    v_mfma_f32_16x16x32_bf16 v[216:219], v[84:87], v[56:59], v[216:219]
    v_mfma_f32_16x16x32_bf16 v[248:251], v[80:83], v[60:63], v[248:251]
    v_mfma_f32_16x16x32_bf16 v[248:251], v[84:87], v[60:63], v[248:251]
    v_mfma_f32_16x16x32_bf16 v[220:223], v[96:99], v[56:59], v[220:223]
    v_mfma_f32_16x16x32_bf16 v[220:223], v[100:103], v[56:59], v[220:223]
    v_mfma_f32_16x16x32_bf16 v[252:255], v[96:99], v[60:63], v[252:255]
    v_mfma_f32_16x16x32_bf16 v[252:255], v[100:103], v[60:63], v[252:255]
    s_waitcnt lgkmcnt(13)
    v_mfma_f32_16x16x32_bf16 v[216:219], v[72:75], v[32:35], v[216:219]
    v_mfma_f32_16x16x32_bf16 v[216:219], v[76:79], v[32:35], v[216:219]
    s_waitcnt lgkmcnt(11)
    v_mfma_f32_16x16x32_bf16 v[248:251], v[72:75], v[36:39], v[248:251]
    v_mfma_f32_16x16x32_bf16 v[248:251], v[76:79], v[36:39], v[248:251]
    ds_read_b64 v[56:57], v16 offset:960
    ds_read_b64 v[58:59], v16 offset:968
    ds_read_b64 v[60:61], v16 offset:2112
    ds_read_b64 v[62:63], v16 offset:2120
    v_mfma_f32_16x16x32_bf16 v[220:223], v[88:91], v[32:35], v[220:223]
    v_mfma_f32_16x16x32_bf16 v[220:223], v[92:95], v[32:35], v[220:223]
    v_mfma_f32_16x16x32_bf16 v[252:255], v[88:91], v[36:39], v[252:255]
    v_mfma_f32_16x16x32_bf16 v[252:255], v[92:95], v[36:39], v[252:255]
    v_add_f32 v213, v213, v244
    v_add_f32 v214, v214, v245
    v_add_f32 v215, v215, v246
    ds_write_b32 v19, v247 offset:1280
    ds_write_b128 v18, v[212:215] offset:5120
    ds_write_b32 v20, v29 offset:160
    s_waitcnt lgkmcnt(15)
    v_mfma_f32_16x16x32_bf16 v[216:219], v[64:67], v[40:43], v[216:219]
    v_mfma_f32_16x16x32_bf16 v[216:219], v[68:71], v[40:43], v[216:219]
    s_waitcnt lgkmcnt(14)
    v_mfma_f32_16x16x32_bf16 v[248:251], v[64:67], v[44:47], v[248:251]
    v_mfma_f32_16x16x32_bf16 v[248:251], v[68:71], v[44:47], v[248:251]
    v_mfma_f32_16x16x32_bf16 v[220:223], v[80:83], v[40:43], v[220:223]
    v_mfma_f32_16x16x32_bf16 v[220:223], v[84:87], v[40:43], v[220:223]
    v_mfma_f32_16x16x32_bf16 v[252:255], v[80:83], v[44:47], v[252:255]
    v_mfma_f32_16x16x32_bf16 v[252:255], v[84:87], v[44:47], v[252:255]
    s_waitcnt lgkmcnt(9)
    v_mfma_f32_16x16x32_bf16 v[220:223], v[72:75], v[48:51], v[220:223]
    v_mfma_f32_16x16x32_bf16 v[220:223], v[76:79], v[48:51], v[220:223]
    s_waitcnt lgkmcnt(7)
    v_mfma_f32_16x16x32_bf16 v[252:255], v[72:75], v[52:55], v[252:255]
    v_mfma_f32_16x16x32_bf16 v[252:255], v[76:79], v[52:55], v[252:255]
    s_nop 3
    v_add_f32 v217, v217, v248
    v_add_f32 v218, v218, v249
    v_add_f32 v219, v219, v250
    ds_write_b32 v19, v251 offset:1536
    ds_write_b128 v18, v[216:219] offset:6144
    ds_write_b32 v20, v29 offset:192
    s_waitcnt lgkmcnt(8)
    v_mfma_f32_16x16x32_bf16 v[220:223], v[64:67], v[56:59], v[220:223]
    v_mfma_f32_16x16x32_bf16 v[220:223], v[68:71], v[56:59], v[220:223]
    s_waitcnt lgkmcnt(6)
    v_mfma_f32_16x16x32_bf16 v[252:255], v[64:67], v[60:63], v[252:255]
    v_mfma_f32_16x16x32_bf16 v[252:255], v[68:71], v[60:63], v[252:255]
    s_nop 7
    v_add_f32 v221, v221, v252
    v_add_f32 v222, v222, v253
    v_add_f32 v223, v223, v254
    ds_write_b32 v19, v255 offset:1792
    ds_write_b128 v18, v[220:223] offset:7168
    ds_write_b32 v20, v29 offset:224
    s_branch K_fin
K_convB:
W11_p:
    ds_read_b128 v[24:27], v30 offset:144
    s_waitcnt lgkmcnt(0)
    v_and_b32 v24, v24, v25
    v_and_b32 v26, v26, v27
    v_and_b32 v24, v24, v26
    s_nop 0
    v_readfirstlane_b32 s4, v24
    s_cmp_eq_u32 s4, 1
    s_cbranch_scc1 W11_d
    s_sleep 1
    s_branch W11_p
W11_d:
    buffer_load_dwordx4 v[12:15], v9, s[44:47], s60 offen sc1
    buffer_load_dwordx4 v[24:27], v9, s[44:47], s60 offen offset:1024 sc1
    ds_read_b64 v[32:33], v16 offset:0
    ds_read_b64 v[34:35], v16 offset:8
    ds_read_b64 v[36:37], v16 offset:1152
    ds_read_b64 v[38:39], v16 offset:1160
    ds_read_b64 v[40:41], v16 offset:64
    ds_read_b64 v[42:43], v16 offset:72
    ds_read_b64 v[44:45], v16 offset:1216
    ds_read_b64 v[46:47], v16 offset:1224
    ds_read_b64 v[48:49], v16 offset:128
    ds_read_b64 v[50:51], v16 offset:136
    ds_read_b64 v[52:53], v16 offset:1280
    ds_read_b64 v[54:55], v16 offset:1288
    s_waitcnt lgkmcnt(10)
    v_mfma_f32_16x16x32_bf16 v[192:195], v[68:71], v[32:35], 0
    s_waitcnt lgkmcnt(8)
    v_mfma_f32_16x16x32_bf16 v[224:227], v[68:71], v[36:39], 0
    ds_read_b64 v[56:57], v16 offset:192
    ds_read_b64 v[58:59], v16 offset:200
    ds_read_b64 v[60:61], v16 offset:1344
    ds_read_b64 v[62:63], v16 offset:1352
    v_mfma_f32_16x16x32_bf16 v[196:199], v[76:79], v[32:35], 0
    v_mfma_f32_16x16x32_bf16 v[228:231], v[76:79], v[36:39], 0
    v_mfma_f32_16x16x32_bf16 v[200:203], v[84:87], v[32:35], 0
    v_mfma_f32_16x16x32_bf16 v[232:235], v[84:87], v[36:39], 0
    v_mfma_f32_16x16x32_bf16 v[204:207], v[92:95], v[32:35], 0
    v_mfma_f32_16x16x32_bf16 v[236:239], v[92:95], v[36:39], 0
    v_mfma_f32_16x16x32_bf16 v[208:211], v[100:103], v[32:35], 0
    v_mfma_f32_16x16x32_bf16 v[240:243], v[100:103], v[36:39], 0
    v_mfma_f32_16x16x32_bf16 v[212:215], v[108:111], v[32:35], 0
    v_mfma_f32_16x16x32_bf16 v[244:247], v[108:111], v[36:39], 0
    v_mfma_f32_16x16x32_bf16 v[216:219], v[116:119], v[32:35], 0
    v_mfma_f32_16x16x32_bf16 v[248:251], v[116:119], v[36:39], 0
    v_mfma_f32_16x16x32_bf16 v[220:223], v[124:127], v[32:35], 0
    v_mfma_f32_16x16x32_bf16 v[252:255], v[124:127], v[36:39], 0
    s_waitcnt lgkmcnt(10)
    v_mfma_f32_16x16x32_bf16 v[192:195], v[64:67], v[40:43], v[192:195]
    s_waitcnt lgkmcnt(8)
    v_mfma_f32_16x16x32_bf16 v[224:227], v[64:67], v[44:47], v[224:227]
    ds_read_b64 v[32:33], v16 offset:256
    ds_read_b64 v[34:35], v16 offset:264
    ds_read_b64 v[36:37], v16 offset:1408
    ds_read_b64 v[38:39], v16 offset:1416
    v_mfma_f32_16x16x32_bf16 v[196:199], v[72:75], v[40:43], v[196:199]
    v_mfma_f32_16x16x32_bf16 v[228:231], v[72:75], v[44:47], v[228:231]
    v_mfma_f32_16x16x32_bf16 v[200:203], v[80:83], v[40:43], v[200:203]
    v_mfma_f32_16x16x32_bf16 v[232:235], v[80:83], v[44:47], v[232:235]
    v_mfma_f32_16x16x32_bf16 v[204:207], v[88:91], v[40:43], v[204:207]
    v_mfma_f32_16x16x32_bf16 v[236:239], v[88:91], v[44:47], v[236:239]
    v_mfma_f32_16x16x32_bf16 v[208:211], v[96:99], v[40:43], v[208:211]
    v_mfma_f32_16x16x32_bf16 v[240:243], v[96:99], v[44:47], v[240:243]
    v_mfma_f32_16x16x32_bf16 v[212:215], v[104:107], v[40:43], v[212:215]
    v_mfma_f32_16x16x32_bf16 v[244:247], v[104:107], v[44:47], v[244:247]
    v_mfma_f32_16x16x32_bf16 v[216:219], v[112:115], v[40:43], v[216:219]
    v_mfma_f32_16x16x32_bf16 v[248:251], v[112:115], v[44:47], v[248:251]
    v_mfma_f32_16x16x32_bf16 v[220:223], v[120:123], v[40:43], v[220:223]
    v_mfma_f32_16x16x32_bf16 v[252:255], v[120:123], v[44:47], v[252:255]
    s_waitcnt lgkmcnt(10)
    v_mfma_f32_16x16x32_bf16 v[196:199], v[68:71], v[48:51], v[196:199]
    s_waitcnt lgkmcnt(8)
    v_mfma_f32_16x16x32_bf16 v[228:231], v[68:71], v[52:55], v[228:231]
    ds_read_b64 v[40:41], v16 offset:320
    ds_read_b64 v[42:43], v16 offset:328
    ds_read_b64 v[44:45], v16 offset:1472
    ds_read_b64 v[46:47], v16 offset:1480
    v_mfma_f32_16x16x32_bf16 v[200:203], v[76:79], v[48:51], v[200:203]
    v_mfma_f32_16x16x32_bf16 v[232:235], v[76:79], v[52:55], v[232:235]
    v_add_f32 v193, v193, v224
    v_add_f32 v194, v194, v225
    v_add_f32 v195, v195, v226
    ds_write_b32 v19, v227 offset:0
    ds_write_b128 v18, v[192:195] offset:0
    ds_write_b32 v20, v29 offset:0
    v_mfma_f32_16x16x32_bf16 v[204:207], v[84:87], v[48:51], v[204:207]
    v_mfma_f32_16x16x32_bf16 v[236:239], v[84:87], v[52:55], v[236:239]
    v_mfma_f32_16x16x32_bf16 v[208:211], v[92:95], v[48:51], v[208:211]
    v_mfma_f32_16x16x32_bf16 v[240:243], v[92:95], v[52:55], v[240:243]
    v_mfma_f32_16x16x32_bf16 v[212:215], v[100:103], v[48:51], v[212:215]
    v_mfma_f32_16x16x32_bf16 v[244:247], v[100:103], v[52:55], v[244:247]
    v_mfma_f32_16x16x32_bf16 v[216:219], v[108:111], v[48:51], v[216:219]
    v_mfma_f32_16x16x32_bf16 v[248:251], v[108:111], v[52:55], v[248:251]
    v_mfma_f32_16x16x32_bf16 v[220:223], v[116:119], v[48:51], v[220:223]
    v_mfma_f32_16x16x32_bf16 v[252:255], v[116:119], v[52:55], v[252:255]
    s_waitcnt lgkmcnt(13)
    v_mfma_f32_16x16x32_bf16 v[196:199], v[64:67], v[56:59], v[196:199]
    s_waitcnt lgkmcnt(11)
    v_mfma_f32_16x16x32_bf16 v[228:231], v[64:67], v[60:63], v[228:231]
    ds_read_b64 v[48:49], v16 offset:384
    ds_read_b64 v[50:51], v16 offset:392
    ds_read_b64 v[52:53], v16 offset:1536
    ds_read_b64 v[54:55], v16 offset:1544
    v_mfma_f32_16x16x32_bf16 v[200:203], v[72:75], v[56:59], v[200:203]
    v_mfma_f32_16x16x32_bf16 v[232:235], v[72:75], v[60:63], v[232:235]
    v_mfma_f32_16x16x32_bf16 v[204:207], v[80:83], v[56:59], v[204:207]
    v_mfma_f32_16x16x32_bf16 v[236:239], v[80:83], v[60:63], v[236:239]
    v_mfma_f32_16x16x32_bf16 v[208:211], v[88:91], v[56:59], v[208:211]
    v_mfma_f32_16x16x32_bf16 v[240:243], v[88:91], v[60:63], v[240:243]
    v_mfma_f32_16x16x32_bf16 v[212:215], v[96:99], v[56:59], v[212:215]
    v_mfma_f32_16x16x32_bf16 v[244:247], v[96:99], v[60:63], v[244:247]
    v_mfma_f32_16x16x32_bf16 v[216:219], v[104:107], v[56:59], v[216:219]
    v_mfma_f32_16x16x32_bf16 v[248:251], v[104:107], v[60:63], v[248:251]
    v_mfma_f32_16x16x32_bf16 v[220:223], v[112:115], v[56:59], v[220:223]
    v_mfma_f32_16x16x32_bf16 v[252:255], v[112:115], v[60:63], v[252:255]
    s_waitcnt lgkmcnt(13)
    v_mfma_f32_16x16x32_bf16 v[200:203], v[68:71], v[32:35], v[200:203]
    s_waitcnt lgkmcnt(11)
    v_mfma_f32_16x16x32_bf16 v[232:235], v[68:71], v[36:39], v[232:235]
    ds_read_b64 v[56:57], v16 offset:448
    ds_read_b64 v[58:59], v16 offset:456
    ds_read_b64 v[60:61], v16 offset:1600
    ds_read_b64 v[62:63], v16 offset:1608
    v_mfma_f32_16x16x32_bf16 v[204:207], v[76:79], v[32:35], v[204:207]
    v_mfma_f32_16x16x32_bf16 v[236:239], v[76:79], v[36:39], v[236:239]
    v_add_f32 v197, v197, v228
    v_add_f32 v198, v198, v229
    v_add_f32 v199, v199, v230
    ds_write_b32 v19, v231 offset:256
    ds_write_b128 v18, v[196:199] offset:1024
    ds_write_b32 v20, v29 offset:32
    v_mfma_f32_16x16x32_bf16 v[208:211], v[84:87], v[32:35], v[208:211]
    v_mfma_f32_16x16x32_bf16 v[240:243], v[84:87], v[36:39], v[240:243]
    v_mfma_f32_16x16x32_bf16 v[212:215], v[92:95], v[32:35], v[212:215]
    v_mfma_f32_16x16x32_bf16 v[244:247], v[92:95], v[36:39], v[244:247]
    v_mfma_f32_16x16x32_bf16 v[216:219], v[100:103], v[32:35], v[216:219]
    v_mfma_f32_16x16x32_bf16 v[248:251], v[100:103], v[36:39], v[248:251]
    v_mfma_f32_16x16x32_bf16 v[220:223], v[108:111], v[32:35], v[220:223]
    v_mfma_f32_16x16x32_bf16 v[252:255], v[108:111], v[36:39], v[252:255]
    s_waitcnt lgkmcnt(15)
    v_mfma_f32_16x16x32_bf16 v[200:203], v[64:67], v[40:43], v[200:203]
    s_waitcnt lgkmcnt(14)
    v_mfma_f32_16x16x32_bf16 v[232:235], v[64:67], v[44:47], v[232:235]
    ds_read_b64 v[32:33], v16 offset:512
    ds_read_b64 v[34:35], v16 offset:520
    ds_read_b64 v[36:37], v16 offset:1664
    ds_read_b64 v[38:39], v16 offset:1672
    v_mfma_f32_16x16x32_bf16 v[204:207], v[72:75], v[40:43], v[204:207]
    v_mfma_f32_16x16x32_bf16 v[236:239], v[72:75], v[44:47], v[236:239]
    v_mfma_f32_16x16x32_bf16 v[208:211], v[80:83], v[40:43], v[208:211]
    v_mfma_f32_16x16x32_bf16 v[240:243], v[80:83], v[44:47], v[240:243]
    v_mfma_f32_16x16x32_bf16 v[212:215], v[88:91], v[40:43], v[212:215]
    v_mfma_f32_16x16x32_bf16 v[244:247], v[88:91], v[44:47], v[244:247]
    v_mfma_f32_16x16x32_bf16 v[216:219], v[96:99], v[40:43], v[216:219]
    v_mfma_f32_16x16x32_bf16 v[248:251], v[96:99], v[44:47], v[248:251]
    v_mfma_f32_16x16x32_bf16 v[220:223], v[104:107], v[40:43], v[220:223]
    v_mfma_f32_16x16x32_bf16 v[252:255], v[104:107], v[44:47], v[252:255]
    s_waitcnt lgkmcnt(13)
    v_mfma_f32_16x16x32_bf16 v[204:207], v[68:71], v[48:51], v[204:207]
    s_waitcnt lgkmcnt(11)
    v_mfma_f32_16x16x32_bf16 v[236:239], v[68:71], v[52:55], v[236:239]
    ds_read_b64 v[40:41], v16 offset:576
    ds_read_b64 v[42:43], v16 offset:584
    ds_read_b64 v[44:45], v16 offset:1728
    ds_read_b64 v[46:47], v16 offset:1736
    v_mfma_f32_16x16x32_bf16 v[208:211], v[76:79], v[48:51], v[208:211]
    v_mfma_f32_16x16x32_bf16 v[240:243], v[76:79], v[52:55], v[240:243]
    v_add_f32 v201, v201, v232
    v_add_f32 v202, v202, v233
    v_add_f32 v203, v203, v234
    ds_write_b32 v19, v235 offset:512
    ds_write_b128 v18, v[200:203] offset:2048
    ds_write_b32 v20, v29 offset:64
    v_mfma_f32_16x16x32_bf16 v[212:215], v[84:87], v[48:51], v[212:215]
    v_mfma_f32_16x16x32_bf16 v[244:247], v[84:87], v[52:55], v[244:247]
    v_mfma_f32_16x16x32_bf16 v[216:219], v[92:95], v[48:51], v[216:219]
    v_mfma_f32_16x16x32_bf16 v[248:251], v[92:95], v[52:55], v[248:251]
    v_mfma_f32_16x16x32_bf16 v[220:223], v[100:103], v[48:51], v[220:223]
    v_mfma_f32_16x16x32_bf16 v[252:255], v[100:103], v[52:55], v[252:255]
    s_waitcnt lgkmcnt(15)
    v_mfma_f32_16x16x32_bf16 v[204:207], v[64:67], v[56:59], v[204:207]
    s_waitcnt lgkmcnt(14)
    v_mfma_f32_16x16x32_bf16 v[236:239], v[64:67], v[60:63], v[236:239]
    ds_read_b64 v[48:49], v16 offset:640
    ds_read_b64 v[50:51], v16 offset:648
    ds_read_b64 v[52:53], v16 offset:1792
    ds_read_b64 v[54:55], v16 offset:1800
    v_mfma_f32_16x16x32_bf16 v[208:211], v[72:75], v[56:59], v[208:211]
    v_mfma_f32_16x16x32_bf16 v[240:243], v[72:75], v[60:63], v[240:243]
    v_mfma_f32_16x16x32_bf16 v[212:215], v[80:83], v[56:59], v[212:215]
    v_mfma_f32_16x16x32_bf16 v[244:247], v[80:83], v[60:63], v[244:247]
    v_mfma_f32_16x16x32_bf16 v[216:219], v[88:91], v[56:59], v[216:219]
    v_mfma_f32_16x16x32_bf16 v[248:251], v[88:91], v[60:63], v[248:251]
    v_mfma_f32_16x16x32_bf16 v[220:223], v[96:99], v[56:59], v[220:223]
    v_mfma_f32_16x16x32_bf16 v[252:255], v[96:99], v[60:63], v[252:255]
    s_waitcnt lgkmcnt(13)
    v_mfma_f32_16x16x32_bf16 v[208:211], v[68:71], v[32:35], v[208:211]
    s_waitcnt lgkmcnt(11)
    v_mfma_f32_16x16x32_bf16 v[240:243], v[68:71], v[36:39], v[240:243]
    ds_read_b64 v[56:57], v16 offset:704
    ds_read_b64 v[58:59], v16 offset:712
    ds_read_b64 v[60:61], v16 offset:1856
    ds_read_b64 v[62:63], v16 offset:1864
    v_mfma_f32_16x16x32_bf16 v[212:215], v[76:79], v[32:35], v[212:215]
    v_mfma_f32_16x16x32_bf16 v[244:247], v[76:79], v[36:39], v[244:247]
    v_add_f32 v205, v205, v236
    v_add_f32 v206, v206, v237
    v_add_f32 v207, v207, v238
    ds_write_b32 v19, v239 offset:768
    ds_write_b128 v18, v[204:207] offset:3072
    ds_write_b32 v20, v29 offset:96
    v_mfma_f32_16x16x32_bf16 v[216:219], v[84:87], v[32:35], v[216:219]
    v_mfma_f32_16x16x32_bf16 v[248:251], v[84:87], v[36:39], v[248:251]
    v_mfma_f32_16x16x32_bf16 v[220:223], v[92:95], v[32:35], v[220:223]
    v_mfma_f32_16x16x32_bf16 v[252:255], v[92:95], v[36:39], v[252:255]
    s_waitcnt lgkmcnt(15)
    v_mfma_f32_16x16x32_bf16 v[208:211], v[64:67], v[40:43], v[208:211]
    s_waitcnt lgkmcnt(14)
    v_mfma_f32_16x16x32_bf16 v[240:243], v[64:67], v[44:47], v[240:243]
    ds_read_b64 v[32:33], v16 offset:768
    ds_read_b64 v[34:35], v16 offset:776
    ds_read_b64 v[36:37], v16 offset:1920
    ds_read_b64 v[38:39], v16 offset:1928
    v_mfma_f32_16x16x32_bf16 v[212:215], v[72:75], v[40:43], v[212:215]
    v_mfma_f32_16x16x32_bf16 v[244:247], v[72:75], v[44:47], v[244:247]
    v_mfma_f32_16x16x32_bf16 v[216:219], v[80:83], v[40:43], v[216:219]
    v_mfma_f32_16x16x32_bf16 v[248:251], v[80:83], v[44:47], v[248:251]
    v_mfma_f32_16x16x32_bf16 v[220:223], v[88:91], v[40:43], v[220:223]
    v_mfma_f32_16x16x32_bf16 v[252:255], v[88:91], v[44:47], v[252:255]
    s_waitcnt lgkmcnt(13)
    v_mfma_f32_16x16x32_bf16 v[212:215], v[68:71], v[48:51], v[212:215]
    s_waitcnt lgkmcnt(11)
    v_mfma_f32_16x16x32_bf16 v[244:247], v[68:71], v[52:55], v[244:247]
    ds_read_b64 v[40:41], v16 offset:832
    ds_read_b64 v[42:43], v16 offset:840
    ds_read_b64 v[44:45], v16 offset:1984
    ds_read_b64 v[46:47], v16 offset:1992
    v_mfma_f32_16x16x32_bf16 v[216:219], v[76:79], v[48:51], v[216:219]
    v_mfma_f32_16x16x32_bf16 v[248:251], v[76:79], v[52:55], v[248:251]
    v_add_f32 v209, v209, v240
    v_add_f32 v210, v210, v241
    v_add_f32 v211, v211, v242
    ds_write_b32 v19, v243 offset:1024
    ds_write_b128 v18, v[208:211] offset:4096
    ds_write_b32 v20, v29 offset:128
    v_mfma_f32_16x16x32_bf16 v[220:223], v[84:87], v[48:51], v[220:223]
    v_mfma_f32_16x16x32_bf16 v[252:255], v[84:87], v[52:55], v[252:255]
    s_waitcnt lgkmcnt(15)
    v_mfma_f32_16x16x32_bf16 v[212:215], v[64:67], v[56:59], v[212:215]
    s_waitcnt lgkmcnt(14)
    v_mfma_f32_16x16x32_bf16 v[244:247], v[64:67], v[60:63], v[244:247]
    ds_read_b64 v[48:49], v16 offset:896
    ds_read_b64 v[50:51], v16 offset:904
    ds_read_b64 v[52:53], v16 offset:2048
    ds_read_b64 v[54:55], v16 offset:2056
    v_mfma_f32_16x16x32_bf16 v[216:219], v[72:75], v[56:59], v[216:219]
    v_mfma_f32_16x16x32_bf16 v[248:251], v[72:75], v[60:63], v[248:251]
    v_mfma_f32_16x16x32_bf16 v[220:223], v[80:83], v[56:59], v[220:223]
    v_mfma_f32_16x16x32_bf16 v[252:255], v[80:83], v[60:63], v[252:255]
    s_waitcnt lgkmcnt(13)
    v_mfma_f32_16x16x32_bf16 v[216:219], v[68:71], v[32:35], v[216:219]
    s_waitcnt lgkmcnt(11)
    v_mfma_f32_16x16x32_bf16 v[248:251], v[68:71], v[36:39], v[248:251]
    ds_read_b64 v[56:57], v16 offset:960
    ds_read_b64 v[58:59], v16 offset:968
    ds_read_b64 v[60:61], v16 offset:2112
    ds_read_b64 v[62:63], v16 offset:2120
    v_mfma_f32_16x16x32_bf16 v[220:223], v[76:79], v[32:35], v[220:223]
    v_mfma_f32_16x16x32_bf16 v[252:255], v[76:79], v[36:39], v[252:255]
    v_add_f32 v213, v213, v244
    v_add_f32 v214, v214, v245
    v_add_f32 v215, v215, v246
    ds_write_b32 v19, v247 offset:1280
    ds_write_b128 v18, v[212:215] offset:5120
    ds_write_b32 v20, v29 offset:160
    s_waitcnt lgkmcnt(15)
    v_mfma_f32_16x16x32_bf16 v[216:219], v[64:67], v[40:43], v[216:219]
    s_waitcnt lgkmcnt(14)
    v_mfma_f32_16x16x32_bf16 v[248:251], v[64:67], v[44:47], v[248:251]
    v_mfma_f32_16x16x32_bf16 v[220:223], v[72:75], v[40:43], v[220:223]
    v_mfma_f32_16x16x32_bf16 v[252:255], v[72:75], v[44:47], v[252:255]
    s_waitcnt lgkmcnt(9)
    v_mfma_f32_16x16x32_bf16 v[220:223], v[68:71], v[48:51], v[220:223]
    s_waitcnt lgkmcnt(7)
    v_mfma_f32_16x16x32_bf16 v[252:255], v[68:71], v[52:55], v[252:255]
    s_nop 3
    v_add_f32 v217, v217, v248
    v_add_f32 v218, v218, v249
    v_add_f32 v219, v219, v250
    ds_write_b32 v19, v251 offset:1536
    ds_write_b128 v18, v[216:219] offset:6144
    ds_write_b32 v20, v29 offset:192
    s_waitcnt lgkmcnt(8)
    v_mfma_f32_16x16x32_bf16 v[220:223], v[64:67], v[56:59], v[220:223]
    s_waitcnt lgkmcnt(6)
    v_mfma_f32_16x16x32_bf16 v[252:255], v[64:67], v[60:63], v[252:255]
    s_nop 7
    v_add_f32 v221, v221, v252
    v_add_f32 v222, v222, v253
    v_add_f32 v223, v223, v254
    ds_write_b32 v19, v255 offset:1792
    ds_write_b128 v18, v[220:223] offset:7168
    ds_write_b32 v20, v29 offset:224
    s_mov_b32 s70, 0
K_gpoll:
    s_waitcnt vmcnt(0)
    v_xor_b32 v14, s56, v14
    v_xor_b32 v15, s57, v15
    v_xor_b32 v26, s56, v26
    v_xor_b32 v27, s57, v27
    v_or_b32 v14, v14, v15
    v_or_b32 v26, v26, v27
    v_or_b32 v14, v14, v26
    v_cmp_ne_u32 vcc, 0, v14
    s_add_u32 s70, s70, 1
    s_cmp_eq_u64 vcc, 0
    s_cbranch_scc1 K_gok
    s_cmp_ge_u32 s70, 0x40000
    s_cbranch_scc1 K_gok
    s_sleep 8
    buffer_load_dwordx4 v[12:15], v9, s[44:47], s60 offen sc1
    buffer_load_dwordx4 v[24:27], v9, s[44:47], s60 offen offset:1024 sc1
    s_branch K_gpoll
K_gok:
    v_lshlrev_b32 v32, 16, v12
    v_and_b32 v33, s43, v12
    v_lshlrev_b32 v34, 16, v13
    v_and_b32 v35, s43, v13
    v_sub_f32 v40, 1.0, v32
    v_cvt_pk_bf16_f32 v32, v32, v40
    v_sub_f32 v40, 1.0, v33
    v_cvt_pk_bf16_f32 v33, v33, v40
    v_sub_f32 v40, 1.0, v34
    v_cvt_pk_bf16_f32 v34, v34, v40
    v_sub_f32 v40, 1.0, v35
    v_cvt_pk_bf16_f32 v35, v35, v40
    v_lshlrev_b32 v36, 16, v24
    v_and_b32 v37, s43, v24
    v_lshlrev_b32 v38, 16, v25
    v_and_b32 v39, s43, v25
    v_sub_f32 v40, 1.0, v36
    v_cvt_pk_bf16_f32 v36, v36, v40
    v_sub_f32 v40, 1.0, v37
    v_cvt_pk_bf16_f32 v37, v37, v40
    v_sub_f32 v40, 1.0, v38
    v_cvt_pk_bf16_f32 v38, v38, v40
    v_sub_f32 v40, 1.0, v39
    v_cvt_pk_bf16_f32 v39, v39, v40
    ds_write_b128 v10, v[32:35]
    ds_write_b128 v10, v[36:39] offset:1024
    ds_write_b32 v28, v29 offset:192
    s_setprio 2
K_fin:
W12_p:
    ds_read_b128 v[32:35], v30 offset:208
    s_waitcnt lgkmcnt(0)
    v_and_b32 v32, v32, v33
    v_and_b32 v34, v34, v35
    v_and_b32 v32, v32, v34
    s_nop 0
    v_readfirstlane_b32 s4, v32
    s_cmp_eq_u32 s4, 1
    s_cbranch_scc1 W12_d
    s_sleep 1
    s_branch W12_p
W12_d:
K_hloop:
    v_mov_b32 v48, 0
    v_mov_b32 v49, 0
    v_mov_b32 v50, 0
    v_mov_b32 v51, 0
    ds_read_u16_d16_hi v48, v21 offset:128
    ds_read_u16_d16_hi v49, v21 offset:4736
    ds_read_u16_d16_hi v50, v21 offset:9344
    ds_read_u16_d16_hi v51, v21 offset:13952
    ds_read_b32 v8, v7
K_hpoll:
    ds_read_b128 v[32:35], v23
    ds_read_b128 v[36:39], v23 offset:16
    s_waitcnt lgkmcnt(0)
    v_and_b32 v32, v32, v33
    v_and_b32 v34, v34, v35
    v_and_b32 v36, v36, v37
    v_and_b32 v38, v38, v39
    v_and_b32 v32, v32, v34
    v_and_b32 v36, v36, v38
    v_and_b32 v32, v32, v36
    s_nop 0
    v_readfirstlane_b32 s70, v32
    s_cmp_eq_u32 s70, 1
    s_cbranch_scc1 K_go
    s_sleep 3
    s_branch K_hpoll
K_go:
    ds_read_b32 v32, v2 offset:41088
    ds_read_b32 v36, v3 offset:41088
    ds_read_b32 v40, v11 offset:41088
    ds_read_b32 v33, v2 offset:57504
    ds_read_b32 v37, v3 offset:57504
    ds_read_b32 v41, v11 offset:45216
    ds_read_b32 v34, v2 offset:0
    ds_read_b32 v38, v3 offset:0
    ds_read_b32 v42, v11 offset:0
    ds_read_b32 v35, v2 offset:16416
    ds_read_b32 v39, v3 offset:16416
    ds_read_b32 v43, v11 offset:4128
    v_mul_f32 v52, s76, v48
    v_mul_f32 v53, s77, v49
    v_mul_f32 v54, s78, v50
    v_mul_f32 v55, s79, v51
    v_cvt_pk_bf16_f32 v52, v52, v53
    v_and_b32 v53, s43, v52
    v_lshlrev_b32 v52, 16, v52
    v_cvt_pk_bf16_f32 v54, v54, v55
    v_and_b32 v55, s43, v54
    v_lshlrev_b32 v54, 16, v54
    v_lshlrev_b32 v56, 16, v8
    v_and_b32 v57, s43, v8
    v_add_u32 v2, 1024, v2
    v_add_u32 v3, 1024, v3
    v_add_u32 v11, s75, v11
    v_add_u32 v21, 128, v21
    v_add_u32 v23, 32, v23
    v_add_u32 v7, 1024, v7
    s_waitcnt lgkmcnt(9)
    v_add_f32 v32, v32, v36
    v_add_f32 v32, v32, v40
    s_waitcnt lgkmcnt(6)
    v_add_f32 v33, v33, v37
    v_add_f32 v33, v33, v41
    s_waitcnt lgkmcnt(3)
    v_add_f32 v34, v34, v38
    v_add_f32 v34, v34, v42
    s_waitcnt lgkmcnt(0)
    v_add_f32 v35, v35, v39
    v_add_f32 v35, v35, v43
    v_cvt_pk_bf16_f32 v32, v32, v33
    v_and_b32 v33, s43, v32
    v_lshlrev_b32 v32, 16, v32
    v_cvt_pk_bf16_f32 v34, v34, v35
    v_and_b32 v35, s43, v34
    v_lshlrev_b32 v34, 16, v34
    v_add_f32 v32, v32, v52
    v_add_f32 v33, v33, v53
    v_add_f32 v34, v34, v54
    v_add_f32 v35, v35, v55
    v_cvt_pk_bf16_f32 v32, v32, v33
    v_and_b32 v33, s43, v32
    v_lshlrev_b32 v32, 16, v32
    v_cvt_pk_bf16_f32 v34, v34, v35
    v_and_b32 v35, s43, v34
    v_lshlrev_b32 v34, 16, v34
    v_mul_f32 v34, v48, v34
    v_mul_f32 v35, v49, v35
    v_cvt_pk_bf16_f32 v34, v34, v35
    v_and_b32 v35, s43, v34
    v_lshlrev_b32 v34, 16, v34
    v_mul_f32 v32, v56, v32
    v_mul_f32 v33, v56, v33
    v_mul_f32 v34, v57, v34
    v_mul_f32 v35, v57, v35
    v_cvt_pk_bf16_f32 v32, v32, v33
    v_and_b32 v33, s43, v32
    v_lshlrev_b32 v32, 16, v32
    v_cvt_pk_bf16_f32 v34, v34, v35
    v_and_b32 v35, s43, v34
    v_lshlrev_b32 v34, 16, v34
    v_add_f32 v32, v32, v34
    v_add_f32 v33, v33, v35
    v_cvt_pk_bf16_f32 v32, v32, v33
    buffer_store_dword v32, v22, s[48:51], s72 offen
    v_add_u32 v22, 0x40000, v22
    s_add_u32 s73, s73, 1
    s_cmp_lt_u32 s73, s74
    s_cbranch_scc1 K_hloop
K_end:
    s_endpgm
.section .rodata,"a"
.p2align 6
.amdhsa_kernel gated_mix__ssm_conv_s4__ssm_conv_h3__prompt_kernel
  .amdhsa_next_free_vgpr 256
  .amdhsa_next_free_sgpr 80
  .amdhsa_accum_offset 256
  .amdhsa_group_segment_fixed_size 0
  .amdhsa_kernarg_size 152
  .amdhsa_user_sgpr_count 2
  .amdhsa_user_sgpr_kernarg_segment_ptr 1
  .amdhsa_system_sgpr_workgroup_id_x 1
  .amdhsa_float_denorm_mode_32 3
.end_amdhsa_kernel
```
